```python
import torch

def _softmax(x, axis=-1):
    return torch.softmax(x, dim=axis)
def _gelu(x):
    return torch.nn.functional.gelu(x, approximate="tanh")
def _silu(x):
    return torch.nn.functional.silu(x)
def _sigmoid(x):
    return torch.sigmoid(x)
def _layernorm(x, axis=-1, eps=1e-5):
    m = x.mean(dim=axis, keepdim=True)
    v = x.var(dim=axis, keepdim=True, unbiased=False)
    return (x - m) / torch.sqrt(v + eps)
def _scatter_add(tgt, idx, src, axis=0):
    return tgt.clone().index_add_(axis, idx, src)
def _segment_sum(src, seg, n):
    out = torch.zeros((n,) + src.shape[1:], dtype=src.dtype)
    return out.index_add_(0, seg, src)
def _pad(x, pw):
    flat = tuple(v for pair in reversed(pw) for v in pair)
    return torch.nn.functional.pad(x, flat)

kernel_name = 'standalone__low_rank_proj_linformer__prompt'

def setup_inputs():

    _w = (lambda a: (lambda t: t.to(torch.bfloat16) if t.is_floating_point() else t)(torch.as_tensor(a)))
    B, H, Sq, Skv, Dh, R = 1, 32, 2048, 2048, 192, 64
    return {
        "q": _w((lambda *s: torch.randn(*s, dtype=torch.bfloat16) * 0.8)(B, H, Sq, Dh)),
        "k": _w((lambda *s: torch.randn(*s, dtype=torch.bfloat16) * 0.8)(B, H, Skv, Dh)),
        "v": _w((lambda *s: torch.randn(*s, dtype=torch.bfloat16) * 0.05)(B, H, Skv, Dh)),
        "e_proj": _w((lambda *s: torch.randn(*s, dtype=torch.bfloat16) * 0.8)(R, Skv) * (Skv ** -0.5)),
        "f_proj": _w((lambda *s: torch.randn(*s, dtype=torch.bfloat16) * 0.05)(R, Skv) * (Skv ** -0.5)),
    }

def reference(q, k, v, e_proj, f_proj):
    B, H, Sq, Dh = q.shape
    kp = torch.einsum("rn,bhnd->bhrd", e_proj, k)
    vp = torch.einsum("rn,bhnd->bhrd", f_proj, v)
    scores = torch.einsum("bhqd,bhrd->bhqr", q, kp) * (Dh ** -0.5)
    p = _softmax(scores, axis=-1)
    o = torch.einsum("bhqr,bhrd->bhqd", p, vp)
    return o
```

```asm
; @launch grid=(256,1,1) block=(512,1,1) lds=163840
.amdgcn_target "amdgcn-amd-amdhsa--gfx950"
.text
.globl standalone__low_rank_proj_linformer__prompt_kernel
.p2align 8
.type standalone__low_rank_proj_linformer__prompt_kernel,@function
standalone__low_rank_proj_linformer__prompt_kernel:
    s_cmp_ge_u32 s2, 256
    s_cbranch_scc1 L_END
    s_load_dwordx16 s[4:19], s[0:1], 0
    v_lshrrev_b32 v2, 6, v0
    v_and_b32 v1, 63, v0
    v_readfirstlane_b32 s44, v2
    v_mov_b32 v251, 0x21800
    v_lshl_add_u32 v2, v1, 2, v251
    v_mov_b32 v20, 0
    v_mov_b32 v255, 1
    ds_write_b32 v2, v20
    s_and_b32 s52, s2, 7
    s_lshr_b32 s53, s2, 3
    s_and_b32 s54, s53, 3
    s_lshl_b32 s45, s52, 2
    s_add_u32 s45, s45, s54
    s_lshr_b32 s47, s53, 2
    s_mov_b32 s26, 0x1800000
    s_mov_b32 s27, 0x00020000
    s_mov_b32 s30, 0x40000
    s_mov_b32 s31, 0x00020000
    s_waitcnt lgkmcnt(0)
    s_barrier
    s_cmp_lt_u32 s47, 4
    s_cselect_b32 s24, s6, s8
    s_cselect_b32 s25, s7, s9
    s_cselect_b32 s28, s10, s12
    s_cselect_b32 s29, s11, s13
    s_cmp_ge_u32 s44, 4
    s_cbranch_scc1 L_HELP
    s_cmp_ge_u32 s47, 4
    s_cbranch_scc1 L_PV
    v_and_b32 v4, 15, v1
    v_lshrrev_b32 v5, 4, v1
    v_mul_u32_u24 v3, 3072, v5
    v_mad_u32_u24 v3, v4, 12, v3
    s_mul_i32 s64, s45, 786432
    s_and_b32 s53, s47, 1
    s_mul_i32 s52, s53, 393216
    s_add_u32 s64, s64, s52
    s_and_b32 s52, s47, 2
    s_mul_i32 s52, s52, 96
    s_add_u32 s64, s64, s52
    s_mul_i32 s52, s44, 24576
    s_add_u32 s64, s64, s52
    s_and_b32 s66, s45, 3
    s_mov_b32 s68, s66
    s_mul_i32 s50, s66, 98304
    s_add_u32 s50, s50, s64
    s_add_u32 s66, s66, 1
    s_and_b32 s66, s66, 3
    buffer_load_dwordx3 v[224:226], v3, s[24:27], s50 offen nt
    buffer_load_dwordx3 v[228:230], v3, s[24:27], s50 offen offset:384 nt
    buffer_load_dwordx3 v[232:234], v3, s[24:27], s50 offen offset:768 nt
    buffer_load_dwordx3 v[236:238], v3, s[24:27], s50 offen offset:1152 nt
    buffer_load_dwordx3 v[240:242], v3, s[24:27], s50 offen offset:1536 nt
    buffer_load_dwordx3 v[244:246], v3, s[24:27], s50 offen offset:1920 nt
    buffer_load_dwordx3 v[248:250], v3, s[24:27], s50 offen offset:2304 nt
    buffer_load_dwordx3 v[252:254], v3, s[24:27], s50 offen offset:2688 nt
    s_add_u32 s50, s50, 12288
    buffer_load_dwordx3 v[160:162], v3, s[24:27], s50 offen nt
    buffer_load_dwordx3 v[164:166], v3, s[24:27], s50 offen offset:384 nt
    buffer_load_dwordx3 v[168:170], v3, s[24:27], s50 offen offset:768 nt
    buffer_load_dwordx3 v[172:174], v3, s[24:27], s50 offen offset:1152 nt
    buffer_load_dwordx3 v[176:178], v3, s[24:27], s50 offen offset:1536 nt
    buffer_load_dwordx3 v[180:182], v3, s[24:27], s50 offen offset:1920 nt
    buffer_load_dwordx3 v[184:186], v3, s[24:27], s50 offen offset:2304 nt
    buffer_load_dwordx3 v[188:190], v3, s[24:27], s50 offen offset:2688 nt
    s_mul_i32 s50, s66, 98304
    s_add_u32 s50, s50, s64
    s_add_u32 s66, s66, 1
    s_and_b32 s66, s66, 3
    buffer_load_dwordx3 v[192:194], v3, s[24:27], s50 offen nt
    buffer_load_dwordx3 v[196:198], v3, s[24:27], s50 offen offset:384 nt
    buffer_load_dwordx3 v[200:202], v3, s[24:27], s50 offen offset:768 nt
    buffer_load_dwordx3 v[204:206], v3, s[24:27], s50 offen offset:1152 nt
    buffer_load_dwordx3 v[208:210], v3, s[24:27], s50 offen offset:1536 nt
    buffer_load_dwordx3 v[212:214], v3, s[24:27], s50 offen offset:1920 nt
    buffer_load_dwordx3 v[216:218], v3, s[24:27], s50 offen offset:2304 nt
    buffer_load_dwordx3 v[220:222], v3, s[24:27], s50 offen offset:2688 nt
    s_add_u32 s50, s50, 12288
    buffer_load_dwordx3 v[128:130], v3, s[24:27], s50 offen nt
    buffer_load_dwordx3 v[132:134], v3, s[24:27], s50 offen offset:384 nt
    buffer_load_dwordx3 v[136:138], v3, s[24:27], s50 offen offset:768 nt
    buffer_load_dwordx3 v[140:142], v3, s[24:27], s50 offen offset:1152 nt
    buffer_load_dwordx3 v[144:146], v3, s[24:27], s50 offen offset:1536 nt
    buffer_load_dwordx3 v[148:150], v3, s[24:27], s50 offen offset:1920 nt
    buffer_load_dwordx3 v[152:154], v3, s[24:27], s50 offen offset:2304 nt
    buffer_load_dwordx3 v[156:158], v3, s[24:27], s50 offen offset:2688 nt
    s_lshl_b32 s65, s44, 7
    s_and_b32 s53, s47, 1
    s_lshl_b32 s53, s53, 11
    s_add_u32 s65, s65, s53
    s_lshl_b32 s67, s44, 13
    v_and_b32 v6, 7, v1
    v_xor_b32 v6, v6, v5
    v_lshrrev_b32 v7, 3, v1
    v_lshlrev_b32 v7, 12, v7
    v_lshl_add_u32 v6, v6, 4, v7
    v_xor_b32 v7, 64, v6
    s_lshl_b32 s52, s44, 16
    s_xor_b32 s53, s52, 0x0
    v_add_u32 v131, s53, v6
    s_xor_b32 s53, s52, 0x0
    s_add_u32 s53, s53, 0x7c00
    v_add_u32 v135, s53, v7
    s_xor_b32 s53, s52, 0x10000
    v_add_u32 v139, s53, v6
    s_xor_b32 s53, s52, 0x10000
    s_add_u32 s53, s53, 0x7c00
    v_add_u32 v143, s53, v7
    s_xor_b32 s53, s52, 0x20000
    v_add_u32 v147, s53, v6
    s_xor_b32 s53, s52, 0x20000
    s_add_u32 s53, s53, 0x7c00
    v_add_u32 v151, s53, v7
    s_xor_b32 s53, s52, 0x30000
    v_add_u32 v155, s53, v6
    s_xor_b32 s53, s52, 0x30000
    s_add_u32 s53, s53, 0x7c00
    v_add_u32 v159, s53, v7
    s_lshl_b32 s51, s68, 9
    s_add_u32 s51, s51, s65
    s_add_u32 s68, s68, 1
    s_and_b32 s68, s68, 3
    s_add_u32 m0, s67, 65536
    s_nop 0
    buffer_load_dwordx4 v131, s[28:31], s51 offen lds
    buffer_load_dwordx4 v135, s[28:31], s51 offen offset:1024 lds
    s_add_u32 m0, s67, 67584
    s_nop 0
    buffer_load_dwordx4 v139, s[28:31], s51 offen lds
    buffer_load_dwordx4 v143, s[28:31], s51 offen offset:1024 lds
    s_add_u32 m0, s67, 69632
    s_nop 0
    buffer_load_dwordx4 v147, s[28:31], s51 offen lds
    buffer_load_dwordx4 v151, s[28:31], s51 offen offset:1024 lds
    s_add_u32 m0, s67, 71680
    s_nop 0
    buffer_load_dwordx4 v155, s[28:31], s51 offen lds
    buffer_load_dwordx4 v159, s[28:31], s51 offen offset:1024 lds
    s_lshl_b32 s51, s68, 9
    s_add_u32 s51, s51, s65
    s_add_u32 s68, s68, 1
    s_and_b32 s68, s68, 3
    s_add_u32 m0, s67, 98304
    s_nop 0
    buffer_load_dwordx4 v131, s[28:31], s51 offen lds
    buffer_load_dwordx4 v135, s[28:31], s51 offen offset:1024 lds
    s_add_u32 m0, s67, 100352
    s_nop 0
    buffer_load_dwordx4 v139, s[28:31], s51 offen lds
    buffer_load_dwordx4 v143, s[28:31], s51 offen offset:1024 lds
    s_add_u32 m0, s67, 102400
    s_nop 0
    buffer_load_dwordx4 v147, s[28:31], s51 offen lds
    buffer_load_dwordx4 v151, s[28:31], s51 offen offset:1024 lds
    s_add_u32 m0, s67, 104448
    s_nop 0
    buffer_load_dwordx4 v155, s[28:31], s51 offen lds
    buffer_load_dwordx4 v159, s[28:31], s51 offen offset:1024 lds
    s_lshl_b32 s51, s68, 9
    s_add_u32 s51, s51, s65
    s_add_u32 s68, s68, 1
    s_and_b32 s68, s68, 3
    s_add_u32 m0, s67, 0
    s_nop 0
    buffer_load_dwordx4 v131, s[28:31], s51 offen lds
    buffer_load_dwordx4 v135, s[28:31], s51 offen offset:1024 lds
    s_add_u32 m0, s67, 2048
    s_nop 0
    buffer_load_dwordx4 v139, s[28:31], s51 offen lds
    buffer_load_dwordx4 v143, s[28:31], s51 offen offset:1024 lds
    s_add_u32 m0, s67, 4096
    s_nop 0
    buffer_load_dwordx4 v147, s[28:31], s51 offen lds
    buffer_load_dwordx4 v151, s[28:31], s51 offen offset:1024 lds
    s_add_u32 m0, s67, 6144
    s_nop 0
    buffer_load_dwordx4 v155, s[28:31], s51 offen lds
    buffer_load_dwordx4 v159, s[28:31], s51 offen offset:1024 lds
    v_lshrrev_b32 v6, 1, v4
    v_xor_b32 v6, v6, v5
    v_lshlrev_b32 v6, 4, v6
    v_lshl_add_u32 v6, v4, 7, v6
    v_add_u32 v163, s67, v6
    v_xor_b32 v167, 64, v163
    v_add_u32 v171, 0x10000, v163
    v_add_u32 v223, 0x10000, v167
    s_mov_b32 s48, 0x05040100
    s_mov_b32 s49, 0x07060302
    s_waitcnt vmcnt(48)
    s_lshl_b32 s51, s68, 9
    s_add_u32 s51, s51, s65
    s_add_u32 s68, s68, 1
    s_and_b32 s68, s68, 3
    s_add_u32 m0, s67, 32768
    s_nop 0
    buffer_load_dwordx4 v131, s[28:31], s51 offen lds
    buffer_load_dwordx4 v135, s[28:31], s51 offen offset:1024 lds
    s_add_u32 m0, s67, 34816
    s_nop 0
    buffer_load_dwordx4 v139, s[28:31], s51 offen lds
    buffer_load_dwordx4 v143, s[28:31], s51 offen offset:1024 lds
    s_add_u32 m0, s67, 36864
    s_nop 0
    buffer_load_dwordx4 v147, s[28:31], s51 offen lds
    buffer_load_dwordx4 v151, s[28:31], s51 offen offset:1024 lds
    s_add_u32 m0, s67, 38912
    s_nop 0
    buffer_load_dwordx4 v155, s[28:31], s51 offen lds
    buffer_load_dwordx4 v159, s[28:31], s51 offen offset:1024 lds
    s_waitcnt vmcnt(24)
    ds_read_b128 v[16:19], v171
    ds_read_b128 v[20:23], v171 offset:2048
    ds_read_b128 v[24:27], v171 offset:4096
    ds_read_b128 v[28:31], v171 offset:6144
    v_perm_b32 v4, v228, v224, s48
    v_perm_b32 v5, v236, v232, s48
    v_perm_b32 v6, v244, v240, s48
    v_perm_b32 v7, v252, v248, s48
    s_waitcnt lgkmcnt(0)
    s_nop 0
    v_mfma_f32_16x16x32_bf16 v[32:35], v[4:7], v[16:19], 0
    v_perm_b32 v8, v228, v224, s49
    v_perm_b32 v12, v229, v225, s48
    v_mfma_f32_16x16x32_bf16 v[56:59], v[4:7], v[20:23], 0
    v_perm_b32 v9, v236, v232, s49
    v_perm_b32 v13, v237, v233, s48
    v_mfma_f32_16x16x32_bf16 v[80:83], v[4:7], v[24:27], 0
    v_perm_b32 v10, v244, v240, s49
    v_perm_b32 v14, v245, v241, s48
    v_mfma_f32_16x16x32_bf16 v[104:107], v[4:7], v[28:31], 0
    v_perm_b32 v11, v252, v248, s49
    v_perm_b32 v15, v253, v249, s48
    s_nop 0
    v_mfma_f32_16x16x32_bf16 v[36:39], v[8:11], v[16:19], 0
    v_perm_b32 v4, v229, v225, s49
    v_mfma_f32_16x16x32_bf16 v[60:63], v[8:11], v[20:23], 0
    v_perm_b32 v5, v237, v233, s49
    v_mfma_f32_16x16x32_bf16 v[84:87], v[8:11], v[24:27], 0
    v_perm_b32 v6, v245, v241, s49
    v_mfma_f32_16x16x32_bf16 v[108:111], v[8:11], v[28:31], 0
    v_perm_b32 v7, v253, v249, s49
    v_mfma_f32_16x16x32_bf16 v[40:43], v[12:15], v[16:19], 0
    v_perm_b32 v8, v230, v226, s48
    v_mfma_f32_16x16x32_bf16 v[64:67], v[12:15], v[20:23], 0
    v_perm_b32 v9, v238, v234, s48
    v_mfma_f32_16x16x32_bf16 v[88:91], v[12:15], v[24:27], 0
    v_perm_b32 v10, v246, v242, s48
    v_mfma_f32_16x16x32_bf16 v[112:115], v[12:15], v[28:31], 0
    v_perm_b32 v11, v254, v250, s48
    v_mfma_f32_16x16x32_bf16 v[44:47], v[4:7], v[16:19], 0
    v_perm_b32 v12, v230, v226, s49
    v_mfma_f32_16x16x32_bf16 v[68:71], v[4:7], v[20:23], 0
    v_perm_b32 v13, v238, v234, s49
    v_mfma_f32_16x16x32_bf16 v[92:95], v[4:7], v[24:27], 0
    v_perm_b32 v14, v246, v242, s49
    v_mfma_f32_16x16x32_bf16 v[116:119], v[4:7], v[28:31], 0
    v_perm_b32 v15, v254, v250, s49
    s_mul_i32 s50, s66, 98304
    s_add_u32 s50, s50, s64
    s_add_u32 s66, s66, 1
    s_and_b32 s66, s66, 3
    buffer_load_dwordx3 v[224:226], v3, s[24:27], s50 offen nt
    buffer_load_dwordx3 v[228:230], v3, s[24:27], s50 offen offset:384 nt
    buffer_load_dwordx3 v[232:234], v3, s[24:27], s50 offen offset:768 nt
    buffer_load_dwordx3 v[236:238], v3, s[24:27], s50 offen offset:1152 nt
    buffer_load_dwordx3 v[240:242], v3, s[24:27], s50 offen offset:1536 nt
    buffer_load_dwordx3 v[244:246], v3, s[24:27], s50 offen offset:1920 nt
    buffer_load_dwordx3 v[248:250], v3, s[24:27], s50 offen offset:2304 nt
    buffer_load_dwordx3 v[252:254], v3, s[24:27], s50 offen offset:2688 nt
    v_mfma_f32_16x16x32_bf16 v[48:51], v[8:11], v[16:19], 0
    v_mfma_f32_16x16x32_bf16 v[72:75], v[8:11], v[20:23], 0
    v_mfma_f32_16x16x32_bf16 v[96:99], v[8:11], v[24:27], 0
    v_mfma_f32_16x16x32_bf16 v[120:123], v[8:11], v[28:31], 0
    v_mfma_f32_16x16x32_bf16 v[52:55], v[12:15], v[16:19], 0
    v_mfma_f32_16x16x32_bf16 v[76:79], v[12:15], v[20:23], 0
    v_mfma_f32_16x16x32_bf16 v[100:103], v[12:15], v[24:27], 0
    v_mfma_f32_16x16x32_bf16 v[124:127], v[12:15], v[28:31], 0
    ds_read_b128 v[16:19], v223
    ds_read_b128 v[20:23], v223 offset:2048
    ds_read_b128 v[24:27], v223 offset:4096
    ds_read_b128 v[28:31], v223 offset:6144
    v_perm_b32 v4, v164, v160, s48
    v_perm_b32 v5, v172, v168, s48
    v_perm_b32 v6, v180, v176, s48
    v_perm_b32 v7, v188, v184, s48
    s_waitcnt lgkmcnt(0)
    s_nop 0
    v_mfma_f32_16x16x32_bf16 v[32:35], v[4:7], v[16:19], v[32:35]
    v_perm_b32 v8, v164, v160, s49
    v_perm_b32 v12, v165, v161, s48
    v_mfma_f32_16x16x32_bf16 v[56:59], v[4:7], v[20:23], v[56:59]
    v_perm_b32 v9, v172, v168, s49
    v_perm_b32 v13, v173, v169, s48
    v_mfma_f32_16x16x32_bf16 v[80:83], v[4:7], v[24:27], v[80:83]
    v_perm_b32 v10, v180, v176, s49
    v_perm_b32 v14, v181, v177, s48
    v_mfma_f32_16x16x32_bf16 v[104:107], v[4:7], v[28:31], v[104:107]
    v_perm_b32 v11, v188, v184, s49
    v_perm_b32 v15, v189, v185, s48
    s_nop 0
    v_mfma_f32_16x16x32_bf16 v[36:39], v[8:11], v[16:19], v[36:39]
    v_perm_b32 v4, v165, v161, s49
    v_mfma_f32_16x16x32_bf16 v[60:63], v[8:11], v[20:23], v[60:63]
    v_perm_b32 v5, v173, v169, s49
    v_mfma_f32_16x16x32_bf16 v[84:87], v[8:11], v[24:27], v[84:87]
    v_perm_b32 v6, v181, v177, s49
    v_mfma_f32_16x16x32_bf16 v[108:111], v[8:11], v[28:31], v[108:111]
    v_perm_b32 v7, v189, v185, s49
    v_mfma_f32_16x16x32_bf16 v[40:43], v[12:15], v[16:19], v[40:43]
    v_perm_b32 v8, v166, v162, s48
    v_mfma_f32_16x16x32_bf16 v[64:67], v[12:15], v[20:23], v[64:67]
    v_perm_b32 v9, v174, v170, s48
    v_mfma_f32_16x16x32_bf16 v[88:91], v[12:15], v[24:27], v[88:91]
    v_perm_b32 v10, v182, v178, s48
    v_mfma_f32_16x16x32_bf16 v[112:115], v[12:15], v[28:31], v[112:115]
    v_perm_b32 v11, v190, v186, s48
    v_mfma_f32_16x16x32_bf16 v[44:47], v[4:7], v[16:19], v[44:47]
    v_perm_b32 v12, v166, v162, s49
    v_mfma_f32_16x16x32_bf16 v[68:71], v[4:7], v[20:23], v[68:71]
    v_perm_b32 v13, v174, v170, s49
    v_mfma_f32_16x16x32_bf16 v[92:95], v[4:7], v[24:27], v[92:95]
    v_perm_b32 v14, v182, v178, s49
    v_mfma_f32_16x16x32_bf16 v[116:119], v[4:7], v[28:31], v[116:119]
    v_perm_b32 v15, v190, v186, s49
    s_add_u32 s50, s50, 12288
    buffer_load_dwordx3 v[160:162], v3, s[24:27], s50 offen nt
    buffer_load_dwordx3 v[164:166], v3, s[24:27], s50 offen offset:384 nt
    buffer_load_dwordx3 v[168:170], v3, s[24:27], s50 offen offset:768 nt
    buffer_load_dwordx3 v[172:174], v3, s[24:27], s50 offen offset:1152 nt
    buffer_load_dwordx3 v[176:178], v3, s[24:27], s50 offen offset:1536 nt
    buffer_load_dwordx3 v[180:182], v3, s[24:27], s50 offen offset:1920 nt
    buffer_load_dwordx3 v[184:186], v3, s[24:27], s50 offen offset:2304 nt
    buffer_load_dwordx3 v[188:190], v3, s[24:27], s50 offen offset:2688 nt
    v_mfma_f32_16x16x32_bf16 v[48:51], v[8:11], v[16:19], v[48:51]
    v_mfma_f32_16x16x32_bf16 v[72:75], v[8:11], v[20:23], v[72:75]
    v_mfma_f32_16x16x32_bf16 v[96:99], v[8:11], v[24:27], v[96:99]
    v_mfma_f32_16x16x32_bf16 v[120:123], v[8:11], v[28:31], v[120:123]
    v_mfma_f32_16x16x32_bf16 v[52:55], v[12:15], v[16:19], v[52:55]
    v_mfma_f32_16x16x32_bf16 v[76:79], v[12:15], v[20:23], v[76:79]
    v_mfma_f32_16x16x32_bf16 v[100:103], v[12:15], v[24:27], v[100:103]
    v_mfma_f32_16x16x32_bf16 v[124:127], v[12:15], v[28:31], v[124:127]
    s_waitcnt vmcnt(32)
    ds_read_b128 v[16:19], v171 offset:32768
    ds_read_b128 v[20:23], v171 offset:34816
    ds_read_b128 v[24:27], v171 offset:36864
    ds_read_b128 v[28:31], v171 offset:38912
    v_perm_b32 v4, v196, v192, s48
    v_perm_b32 v5, v204, v200, s48
    v_perm_b32 v6, v212, v208, s48
    v_perm_b32 v7, v220, v216, s48
    s_waitcnt lgkmcnt(0)
    s_mov_b64 exec, 1
    ds_max_u32 v251, v251 offset:36
    s_mov_b64 exec, -1
    v_mfma_f32_16x16x32_bf16 v[32:35], v[4:7], v[16:19], v[32:35]
    v_perm_b32 v8, v196, v192, s49
    v_perm_b32 v12, v197, v193, s48
    v_mfma_f32_16x16x32_bf16 v[56:59], v[4:7], v[20:23], v[56:59]
    v_perm_b32 v9, v204, v200, s49
    v_perm_b32 v13, v205, v201, s48
    v_mfma_f32_16x16x32_bf16 v[80:83], v[4:7], v[24:27], v[80:83]
    v_perm_b32 v10, v212, v208, s49
    v_perm_b32 v14, v213, v209, s48
    v_mfma_f32_16x16x32_bf16 v[104:107], v[4:7], v[28:31], v[104:107]
    v_perm_b32 v11, v220, v216, s49
    v_perm_b32 v15, v221, v217, s48
    s_nop 0
    v_mfma_f32_16x16x32_bf16 v[36:39], v[8:11], v[16:19], v[36:39]
    v_perm_b32 v4, v197, v193, s49
    v_mfma_f32_16x16x32_bf16 v[60:63], v[8:11], v[20:23], v[60:63]
    v_perm_b32 v5, v205, v201, s49
    v_mfma_f32_16x16x32_bf16 v[84:87], v[8:11], v[24:27], v[84:87]
    v_perm_b32 v6, v213, v209, s49
    v_mfma_f32_16x16x32_bf16 v[108:111], v[8:11], v[28:31], v[108:111]
    v_perm_b32 v7, v221, v217, s49
    v_mfma_f32_16x16x32_bf16 v[40:43], v[12:15], v[16:19], v[40:43]
    v_perm_b32 v8, v198, v194, s48
    v_mfma_f32_16x16x32_bf16 v[64:67], v[12:15], v[20:23], v[64:67]
    v_perm_b32 v9, v206, v202, s48
    v_mfma_f32_16x16x32_bf16 v[88:91], v[12:15], v[24:27], v[88:91]
    v_perm_b32 v10, v214, v210, s48
    v_mfma_f32_16x16x32_bf16 v[112:115], v[12:15], v[28:31], v[112:115]
    v_perm_b32 v11, v222, v218, s48
    v_mfma_f32_16x16x32_bf16 v[44:47], v[4:7], v[16:19], v[44:47]
    v_perm_b32 v12, v198, v194, s49
    v_mfma_f32_16x16x32_bf16 v[68:71], v[4:7], v[20:23], v[68:71]
    v_perm_b32 v13, v206, v202, s49
    v_mfma_f32_16x16x32_bf16 v[92:95], v[4:7], v[24:27], v[92:95]
    v_perm_b32 v14, v214, v210, s49
    v_mfma_f32_16x16x32_bf16 v[116:119], v[4:7], v[28:31], v[116:119]
    v_perm_b32 v15, v222, v218, s49
    s_mul_i32 s50, s66, 98304
    s_add_u32 s50, s50, s64
    s_add_u32 s66, s66, 1
    s_and_b32 s66, s66, 3
    buffer_load_dwordx3 v[192:194], v3, s[24:27], s50 offen nt
    buffer_load_dwordx3 v[196:198], v3, s[24:27], s50 offen offset:384 nt
    buffer_load_dwordx3 v[200:202], v3, s[24:27], s50 offen offset:768 nt
    buffer_load_dwordx3 v[204:206], v3, s[24:27], s50 offen offset:1152 nt
    buffer_load_dwordx3 v[208:210], v3, s[24:27], s50 offen offset:1536 nt
    buffer_load_dwordx3 v[212:214], v3, s[24:27], s50 offen offset:1920 nt
    buffer_load_dwordx3 v[216:218], v3, s[24:27], s50 offen offset:2304 nt
    buffer_load_dwordx3 v[220:222], v3, s[24:27], s50 offen offset:2688 nt
    v_mfma_f32_16x16x32_bf16 v[48:51], v[8:11], v[16:19], v[48:51]
    v_mfma_f32_16x16x32_bf16 v[72:75], v[8:11], v[20:23], v[72:75]
    v_mfma_f32_16x16x32_bf16 v[96:99], v[8:11], v[24:27], v[96:99]
    v_mfma_f32_16x16x32_bf16 v[120:123], v[8:11], v[28:31], v[120:123]
    v_mfma_f32_16x16x32_bf16 v[52:55], v[12:15], v[16:19], v[52:55]
    v_mfma_f32_16x16x32_bf16 v[76:79], v[12:15], v[20:23], v[76:79]
    v_mfma_f32_16x16x32_bf16 v[100:103], v[12:15], v[24:27], v[100:103]
    v_mfma_f32_16x16x32_bf16 v[124:127], v[12:15], v[28:31], v[124:127]
    ds_read_b128 v[16:19], v223 offset:32768
    ds_read_b128 v[20:23], v223 offset:34816
    ds_read_b128 v[24:27], v223 offset:36864
    ds_read_b128 v[28:31], v223 offset:38912
    v_perm_b32 v4, v132, v128, s48
    v_perm_b32 v5, v140, v136, s48
    v_perm_b32 v6, v148, v144, s48
    v_perm_b32 v7, v156, v152, s48
    s_waitcnt lgkmcnt(0)
    s_nop 0
    v_mfma_f32_16x16x32_bf16 v[32:35], v[4:7], v[16:19], v[32:35]
    v_perm_b32 v8, v132, v128, s49
    v_perm_b32 v12, v133, v129, s48
    v_mfma_f32_16x16x32_bf16 v[56:59], v[4:7], v[20:23], v[56:59]
    v_perm_b32 v9, v140, v136, s49
    v_perm_b32 v13, v141, v137, s48
    v_mfma_f32_16x16x32_bf16 v[80:83], v[4:7], v[24:27], v[80:83]
    v_perm_b32 v10, v148, v144, s49
    v_perm_b32 v14, v149, v145, s48
    v_mfma_f32_16x16x32_bf16 v[104:107], v[4:7], v[28:31], v[104:107]
    v_perm_b32 v11, v156, v152, s49
    v_perm_b32 v15, v157, v153, s48
    s_nop 0
    v_mfma_f32_16x16x32_bf16 v[36:39], v[8:11], v[16:19], v[36:39]
    v_perm_b32 v4, v133, v129, s49
    v_mfma_f32_16x16x32_bf16 v[60:63], v[8:11], v[20:23], v[60:63]
    v_perm_b32 v5, v141, v137, s49
    v_mfma_f32_16x16x32_bf16 v[84:87], v[8:11], v[24:27], v[84:87]
    v_perm_b32 v6, v149, v145, s49
    v_mfma_f32_16x16x32_bf16 v[108:111], v[8:11], v[28:31], v[108:111]
    v_perm_b32 v7, v157, v153, s49
    v_mfma_f32_16x16x32_bf16 v[40:43], v[12:15], v[16:19], v[40:43]
    v_perm_b32 v8, v134, v130, s48
    v_mfma_f32_16x16x32_bf16 v[64:67], v[12:15], v[20:23], v[64:67]
    v_perm_b32 v9, v142, v138, s48
    v_mfma_f32_16x16x32_bf16 v[88:91], v[12:15], v[24:27], v[88:91]
    v_perm_b32 v10, v150, v146, s48
    v_mfma_f32_16x16x32_bf16 v[112:115], v[12:15], v[28:31], v[112:115]
    v_perm_b32 v11, v158, v154, s48
    v_mfma_f32_16x16x32_bf16 v[44:47], v[4:7], v[16:19], v[44:47]
    v_perm_b32 v12, v134, v130, s49
    v_mfma_f32_16x16x32_bf16 v[68:71], v[4:7], v[20:23], v[68:71]
    v_perm_b32 v13, v142, v138, s49
    v_mfma_f32_16x16x32_bf16 v[92:95], v[4:7], v[24:27], v[92:95]
    v_perm_b32 v14, v150, v146, s49
    v_mfma_f32_16x16x32_bf16 v[116:119], v[4:7], v[28:31], v[116:119]
    v_perm_b32 v15, v158, v154, s49
    s_add_u32 s50, s50, 12288
    buffer_load_dwordx3 v[128:130], v3, s[24:27], s50 offen nt
    buffer_load_dwordx3 v[132:134], v3, s[24:27], s50 offen offset:384 nt
    buffer_load_dwordx3 v[136:138], v3, s[24:27], s50 offen offset:768 nt
    buffer_load_dwordx3 v[140:142], v3, s[24:27], s50 offen offset:1152 nt
    buffer_load_dwordx3 v[144:146], v3, s[24:27], s50 offen offset:1536 nt
    buffer_load_dwordx3 v[148:150], v3, s[24:27], s50 offen offset:1920 nt
    buffer_load_dwordx3 v[152:154], v3, s[24:27], s50 offen offset:2304 nt
    buffer_load_dwordx3 v[156:158], v3, s[24:27], s50 offen offset:2688 nt
    v_mfma_f32_16x16x32_bf16 v[48:51], v[8:11], v[16:19], v[48:51]
    v_mfma_f32_16x16x32_bf16 v[72:75], v[8:11], v[20:23], v[72:75]
    v_mfma_f32_16x16x32_bf16 v[96:99], v[8:11], v[24:27], v[96:99]
    v_mfma_f32_16x16x32_bf16 v[120:123], v[8:11], v[28:31], v[120:123]
    v_mfma_f32_16x16x32_bf16 v[52:55], v[12:15], v[16:19], v[52:55]
    v_mfma_f32_16x16x32_bf16 v[76:79], v[12:15], v[20:23], v[76:79]
    v_mfma_f32_16x16x32_bf16 v[100:103], v[12:15], v[24:27], v[100:103]
    v_mfma_f32_16x16x32_bf16 v[124:127], v[12:15], v[28:31], v[124:127]
    s_waitcnt vmcnt(40)
    ds_read_b128 v[16:19], v163
    ds_read_b128 v[20:23], v163 offset:2048
    ds_read_b128 v[24:27], v163 offset:4096
    ds_read_b128 v[28:31], v163 offset:6144
    s_waitcnt vmcnt(24)
    v_perm_b32 v4, v228, v224, s48
    v_perm_b32 v5, v236, v232, s48
    v_perm_b32 v6, v244, v240, s48
    v_perm_b32 v7, v252, v248, s48
    s_waitcnt lgkmcnt(0)
    s_nop 0
    v_mfma_f32_16x16x32_bf16 v[32:35], v[4:7], v[16:19], v[32:35]
    v_perm_b32 v8, v228, v224, s49
    v_perm_b32 v12, v229, v225, s48
    v_mfma_f32_16x16x32_bf16 v[56:59], v[4:7], v[20:23], v[56:59]
    v_perm_b32 v9, v236, v232, s49
    v_perm_b32 v13, v237, v233, s48
    v_mfma_f32_16x16x32_bf16 v[80:83], v[4:7], v[24:27], v[80:83]
    v_perm_b32 v10, v244, v240, s49
    v_perm_b32 v14, v245, v241, s48
    v_mfma_f32_16x16x32_bf16 v[104:107], v[4:7], v[28:31], v[104:107]
    v_perm_b32 v11, v252, v248, s49
    v_perm_b32 v15, v253, v249, s48
    s_nop 0
    v_mfma_f32_16x16x32_bf16 v[36:39], v[8:11], v[16:19], v[36:39]
    v_perm_b32 v4, v229, v225, s49
    v_mfma_f32_16x16x32_bf16 v[60:63], v[8:11], v[20:23], v[60:63]
    v_perm_b32 v5, v237, v233, s49
    v_mfma_f32_16x16x32_bf16 v[84:87], v[8:11], v[24:27], v[84:87]
    v_perm_b32 v6, v245, v241, s49
    v_mfma_f32_16x16x32_bf16 v[108:111], v[8:11], v[28:31], v[108:111]
    v_perm_b32 v7, v253, v249, s49
    v_mfma_f32_16x16x32_bf16 v[40:43], v[12:15], v[16:19], v[40:43]
    v_perm_b32 v8, v230, v226, s48
    v_mfma_f32_16x16x32_bf16 v[64:67], v[12:15], v[20:23], v[64:67]
    v_perm_b32 v9, v238, v234, s48
    v_mfma_f32_16x16x32_bf16 v[88:91], v[12:15], v[24:27], v[88:91]
    v_perm_b32 v10, v246, v242, s48
    v_mfma_f32_16x16x32_bf16 v[112:115], v[12:15], v[28:31], v[112:115]
    v_perm_b32 v11, v254, v250, s48
    v_mfma_f32_16x16x32_bf16 v[44:47], v[4:7], v[16:19], v[44:47]
    v_perm_b32 v12, v230, v226, s49
    v_mfma_f32_16x16x32_bf16 v[68:71], v[4:7], v[20:23], v[68:71]
    v_perm_b32 v13, v238, v234, s49
    v_mfma_f32_16x16x32_bf16 v[92:95], v[4:7], v[24:27], v[92:95]
    v_perm_b32 v14, v246, v242, s49
    v_mfma_f32_16x16x32_bf16 v[116:119], v[4:7], v[28:31], v[116:119]
    v_perm_b32 v15, v254, v250, s49
    v_mfma_f32_16x16x32_bf16 v[48:51], v[8:11], v[16:19], v[48:51]
    v_mfma_f32_16x16x32_bf16 v[72:75], v[8:11], v[20:23], v[72:75]
    v_mfma_f32_16x16x32_bf16 v[96:99], v[8:11], v[24:27], v[96:99]
    v_mfma_f32_16x16x32_bf16 v[120:123], v[8:11], v[28:31], v[120:123]
    v_mfma_f32_16x16x32_bf16 v[52:55], v[12:15], v[16:19], v[52:55]
    v_mfma_f32_16x16x32_bf16 v[76:79], v[12:15], v[20:23], v[76:79]
    v_mfma_f32_16x16x32_bf16 v[100:103], v[12:15], v[24:27], v[100:103]
    v_mfma_f32_16x16x32_bf16 v[124:127], v[12:15], v[28:31], v[124:127]
    s_mov_b32 s20, s4
    s_mov_b32 s21, s5
    s_mov_b32 s22, 0x1800000
    s_mov_b32 s23, 0x00020000
    s_mov_b32 s32, s14
    s_mov_b32 s33, s15
    s_mov_b32 s34, 0x1800000
    s_mov_b32 s35, 0x00020000
    s_mov_b32 s36, s18
    s_mov_b32 s37, s19
    s_mov_b32 s38, 0x1a0000
    s_mov_b32 s39, 0x00020000
    v_lshrrev_b32 v224, 3, v1
    v_and_b32 v225, 7, v1
    v_mul_u32_u24 v236, 384, v224
    v_lshl_add_u32 v236, v225, 4, v236
    s_lshl_b32 s52, s44, 13
    s_add_u32 s52, s52, 133120
    v_lshrrev_b32 v226, 4, v1
    v_xor_b32 v226, v226, v225
    v_lshlrev_b32 v226, 4, v226
    v_lshl_add_u32 v226, v224, 7, v226
    v_add_u32 v237, s52, v226
    v_xor_b32 v238, 64, v237
    v_and_b32 v224, 31, v1
    v_lshrrev_b32 v225, 5, v1
    v_bfe_u32 v226, v1, 1, 3
    v_xor_b32 v226, v226, v225
    v_lshlrev_b32 v226, 4, v226
    v_lshl_add_u32 v226, v224, 7, v226
    v_add_u32 v239, s52, v226
    v_xor_b32 v240, 32, v239
    v_xor_b32 v241, 64, v239
    v_xor_b32 v242, 96, v239
    v_mul_u32_u24 v243, 12, v224
    v_mul_u32_u24 v226, 1536, v225
    v_add_u32 v243, v243, v226
    v_lshlrev_b32 v244, 4, v1
    v_add_u32 v245, 0x10000, v244
    v_lshlrev_b32 v249, 2, v1
    s_lshl_b32 s52, s47, 3
    s_add_u32 s52, s52, s44
    s_mul_i32 s52, s52, 12288
    s_mul_i32 s56, s45, 786432
    s_add_u32 s56, s56, s52
    s_add_u32 s57, s56, 3072
    s_add_u32 s58, s56, 6144
    s_add_u32 s59, s56, 9216
    s_lshr_b32 s52, s44, 1
    s_xor_b32 s52, s52, s47
    s_and_b32 s69, s52, 1
    v_and_b32 v224, 15, v1
    v_lshrrev_b32 v225, 4, v1
    s_bfe_u32 s52, s44, 0x10001
    s_and_b32 s53, s44, 1
    s_mul_i32 s54, s52, 12288
    s_lshl_b32 s55, s53, 8
    s_add_u32 s54, s54, s55
    s_add_u32 s54, s54, 65536
    v_mul_u32_u24 v226, 1536, v225
    v_lshl_add_u32 v226, v224, 4, v226
    v_add_u32 v246, s54, v226
    s_lshl_b32 s54, s52, 11
    s_lshl_b32 s55, s53, 12
    s_add_u32 s54, s54, s55
    s_add_u32 s54, s54, 90112
    v_lshlrev_b32 v226, 9, v225
    v_lshl_add_u32 v226, v224, 4, v226
    v_add_u32 v247, s54, v226
    s_mul_i32 s60, s45, 53248
    s_xor_b32 s54, s69, s47
    s_mul_i32 s54, s54, 6656
    s_mul_i32 s55, s53, 3328
    s_add_u32 s71, s60, s54
    s_add_u32 s71, s71, s55
    s_add_u32 s72, s71, 4096
    s_mul_i32 s54, s47, 6656
    s_bfe_u32 s52, s47, 0x10001
    s_mul_i32 s55, s52, 6144
    v_add_u32 v246, s55, v246
    s_lshl_b32 s55, s52, 8
    v_add_u32 v247, s55, v247
    s_add_u32 s60, s60, s54
    s_mul_i32 s55, s53, 3328
    s_add_u32 s60, s60, s55
    ds_read_b128 v[16:19], v167
    ds_read_b128 v[20:23], v167 offset:2048
    ds_read_b128 v[24:27], v167 offset:4096
    ds_read_b128 v[28:31], v167 offset:6144
    s_waitcnt vmcnt(16)
    v_perm_b32 v4, v164, v160, s48
    v_perm_b32 v5, v172, v168, s48
    v_perm_b32 v6, v180, v176, s48
    v_perm_b32 v7, v188, v184, s48
    s_waitcnt lgkmcnt(0)
    s_nop 0
    v_mfma_f32_16x16x32_bf16 v[32:35], v[4:7], v[16:19], v[32:35]
    v_perm_b32 v8, v164, v160, s49
    v_perm_b32 v12, v165, v161, s48
    v_mfma_f32_16x16x32_bf16 v[56:59], v[4:7], v[20:23], v[56:59]
    v_perm_b32 v9, v172, v168, s49
    v_perm_b32 v13, v173, v169, s48
    v_mfma_f32_16x16x32_bf16 v[80:83], v[4:7], v[24:27], v[80:83]
    v_perm_b32 v10, v180, v176, s49
    v_perm_b32 v14, v181, v177, s48
    v_mfma_f32_16x16x32_bf16 v[104:107], v[4:7], v[28:31], v[104:107]
    v_perm_b32 v11, v188, v184, s49
    v_perm_b32 v15, v189, v185, s48
    s_nop 0
    v_mfma_f32_16x16x32_bf16 v[36:39], v[8:11], v[16:19], v[36:39]
    v_perm_b32 v4, v165, v161, s49
    v_mfma_f32_16x16x32_bf16 v[60:63], v[8:11], v[20:23], v[60:63]
    v_perm_b32 v5, v173, v169, s49
    v_mfma_f32_16x16x32_bf16 v[84:87], v[8:11], v[24:27], v[84:87]
    v_perm_b32 v6, v181, v177, s49
    v_mfma_f32_16x16x32_bf16 v[108:111], v[8:11], v[28:31], v[108:111]
    v_perm_b32 v7, v189, v185, s49
    v_mfma_f32_16x16x32_bf16 v[40:43], v[12:15], v[16:19], v[40:43]
    v_perm_b32 v8, v166, v162, s48
    v_mfma_f32_16x16x32_bf16 v[64:67], v[12:15], v[20:23], v[64:67]
    v_perm_b32 v9, v174, v170, s48
    v_mfma_f32_16x16x32_bf16 v[88:91], v[12:15], v[24:27], v[88:91]
    v_perm_b32 v10, v182, v178, s48
    v_mfma_f32_16x16x32_bf16 v[112:115], v[12:15], v[28:31], v[112:115]
    v_perm_b32 v11, v190, v186, s48
    v_mfma_f32_16x16x32_bf16 v[44:47], v[4:7], v[16:19], v[44:47]
    v_perm_b32 v12, v166, v162, s49
    v_mfma_f32_16x16x32_bf16 v[68:71], v[4:7], v[20:23], v[68:71]
    v_perm_b32 v13, v174, v170, s49
    v_mfma_f32_16x16x32_bf16 v[92:95], v[4:7], v[24:27], v[92:95]
    v_perm_b32 v14, v182, v178, s49
    v_mfma_f32_16x16x32_bf16 v[116:119], v[4:7], v[28:31], v[116:119]
    v_perm_b32 v15, v190, v186, s49
    s_mov_b64 exec, 1
    ds_add_u32 v251, v255 offset:32
    s_mov_b64 exec, -1
    v_mfma_f32_16x16x32_bf16 v[48:51], v[8:11], v[16:19], v[48:51]
    v_mfma_f32_16x16x32_bf16 v[72:75], v[8:11], v[20:23], v[72:75]
    v_mfma_f32_16x16x32_bf16 v[96:99], v[8:11], v[24:27], v[96:99]
    v_mfma_f32_16x16x32_bf16 v[120:123], v[8:11], v[28:31], v[120:123]
    v_mfma_f32_16x16x32_bf16 v[52:55], v[12:15], v[16:19], v[52:55]
    v_mfma_f32_16x16x32_bf16 v[76:79], v[12:15], v[20:23], v[76:79]
    v_mfma_f32_16x16x32_bf16 v[100:103], v[12:15], v[24:27], v[100:103]
    v_mfma_f32_16x16x32_bf16 v[124:127], v[12:15], v[28:31], v[124:127]
    ds_read_b128 v[16:19], v163 offset:32768
    ds_read_b128 v[20:23], v163 offset:34816
    ds_read_b128 v[24:27], v163 offset:36864
    ds_read_b128 v[28:31], v163 offset:38912
    s_waitcnt vmcnt(8)
    v_perm_b32 v4, v196, v192, s48
    v_perm_b32 v5, v204, v200, s48
    v_perm_b32 v6, v212, v208, s48
    v_perm_b32 v7, v220, v216, s48
    s_waitcnt lgkmcnt(0)
    s_nop 0
    v_mfma_f32_16x16x32_bf16 v[32:35], v[4:7], v[16:19], v[32:35]
    v_perm_b32 v8, v196, v192, s49
    v_perm_b32 v12, v197, v193, s48
    v_mfma_f32_16x16x32_bf16 v[56:59], v[4:7], v[20:23], v[56:59]
    v_perm_b32 v9, v204, v200, s49
    v_perm_b32 v13, v205, v201, s48
    v_mfma_f32_16x16x32_bf16 v[80:83], v[4:7], v[24:27], v[80:83]
    v_perm_b32 v10, v212, v208, s49
    v_perm_b32 v14, v213, v209, s48
    v_mfma_f32_16x16x32_bf16 v[104:107], v[4:7], v[28:31], v[104:107]
    v_perm_b32 v11, v220, v216, s49
    v_perm_b32 v15, v221, v217, s48
    s_nop 0
    v_mfma_f32_16x16x32_bf16 v[36:39], v[8:11], v[16:19], v[36:39]
    v_perm_b32 v4, v197, v193, s49
    v_mfma_f32_16x16x32_bf16 v[60:63], v[8:11], v[20:23], v[60:63]
    v_perm_b32 v5, v205, v201, s49
    v_mfma_f32_16x16x32_bf16 v[84:87], v[8:11], v[24:27], v[84:87]
    v_perm_b32 v6, v213, v209, s49
    v_mfma_f32_16x16x32_bf16 v[108:111], v[8:11], v[28:31], v[108:111]
    v_perm_b32 v7, v221, v217, s49
    v_mfma_f32_16x16x32_bf16 v[40:43], v[12:15], v[16:19], v[40:43]
    v_perm_b32 v8, v198, v194, s48
    v_mfma_f32_16x16x32_bf16 v[64:67], v[12:15], v[20:23], v[64:67]
    v_perm_b32 v9, v206, v202, s48
    v_mfma_f32_16x16x32_bf16 v[88:91], v[12:15], v[24:27], v[88:91]
    v_perm_b32 v10, v214, v210, s48
    v_mfma_f32_16x16x32_bf16 v[112:115], v[12:15], v[28:31], v[112:115]
    v_perm_b32 v11, v222, v218, s48
    v_mfma_f32_16x16x32_bf16 v[44:47], v[4:7], v[16:19], v[44:47]
    v_perm_b32 v12, v198, v194, s49
    v_mfma_f32_16x16x32_bf16 v[68:71], v[4:7], v[20:23], v[68:71]
    v_perm_b32 v13, v206, v202, s49
    v_mfma_f32_16x16x32_bf16 v[92:95], v[4:7], v[24:27], v[92:95]
    v_perm_b32 v14, v214, v210, s49
    v_mfma_f32_16x16x32_bf16 v[116:119], v[4:7], v[28:31], v[116:119]
    v_perm_b32 v15, v222, v218, s49
    v_mfma_f32_16x16x32_bf16 v[48:51], v[8:11], v[16:19], v[48:51]
    v_mfma_f32_16x16x32_bf16 v[72:75], v[8:11], v[20:23], v[72:75]
    v_mfma_f32_16x16x32_bf16 v[96:99], v[8:11], v[24:27], v[96:99]
    v_mfma_f32_16x16x32_bf16 v[120:123], v[8:11], v[28:31], v[120:123]
    v_mfma_f32_16x16x32_bf16 v[52:55], v[12:15], v[16:19], v[52:55]
    v_mfma_f32_16x16x32_bf16 v[76:79], v[12:15], v[20:23], v[76:79]
    v_mfma_f32_16x16x32_bf16 v[100:103], v[12:15], v[24:27], v[100:103]
    v_mfma_f32_16x16x32_bf16 v[124:127], v[12:15], v[28:31], v[124:127]
    s_nop 7
L_LP_1:
    ds_read_b32 v9, v251 offset:16
    s_waitcnt lgkmcnt(0)
    v_cmp_gt_u32 vcc, 1, v9
    s_cbranch_vccnz L_LP_1
    v_readfirstlane_b32 s46, v9
    ds_read_b32 v248, v251 offset:72
    ds_read_b128 v[16:19], v167 offset:32768
    ds_read_b128 v[20:23], v167 offset:34816
    ds_read_b128 v[24:27], v167 offset:36864
    ds_read_b128 v[28:31], v167 offset:38912
    v_add_u32 v220, s67, v244
    v_add_u32 v12, 0x20000, v220
    s_lshl_b32 s52, s44, 2
    v_add_u32 v13, s52, v251
    s_xor_b32 s53, s67, 8192
    v_add_u32 v221, s53, v244
    s_xor_b32 s53, s67, 16384
    v_add_u32 v222, s53, v244
    s_xor_b32 s53, s67, 24576
    v_add_u32 v223, s53, v244
    v_add_u32 v14, 0x20000, v223
    s_and_b32 s55, s45, 3
    s_bitcmp1_b32 10, s55
    s_cselect_b32 s77, 1, 0
    v_and_b32 v10, 3, v1
    v_lshl_add_u32 v10, v10, 2, v251
    s_mov_b32 s70, 0x7f800000
    v_mov_b32 v6, 0x7800000
    s_sub_u32 s73, 2, s69
    s_waitcnt vmcnt(6)
    v_perm_b32 v160, v132, v128, s48
    v_perm_b32 v164, v132, v128, s49
    v_perm_b32 v168, v133, v129, s48
    v_perm_b32 v224, v133, v129, s49
    v_perm_b32 v228, v134, v130, s48
    v_perm_b32 v232, v134, v130, s49
    s_waitcnt vmcnt(4)
    v_perm_b32 v161, v140, v136, s48
    v_perm_b32 v165, v140, v136, s49
    v_perm_b32 v169, v141, v137, s48
    v_perm_b32 v225, v141, v137, s49
    v_perm_b32 v229, v142, v138, s48
    v_perm_b32 v233, v142, v138, s49
    s_waitcnt vmcnt(2)
    v_perm_b32 v162, v148, v144, s48
    v_perm_b32 v166, v148, v144, s49
    v_perm_b32 v170, v149, v145, s48
    v_perm_b32 v226, v149, v145, s49
    v_perm_b32 v230, v150, v146, s48
    v_perm_b32 v234, v150, v146, s49
    s_cmp_eq_u32 s69, 0
    s_nop 0
    s_cbranch_scc1 L_LCK_3
    s_waitcnt vmcnt(0)
    v_perm_b32 v163, v156, v152, s48
    v_perm_b32 v167, v156, v152, s49
    v_perm_b32 v171, v157, v153, s48
    s_waitcnt lgkmcnt(0)
    v_mfma_f32_16x16x32_bf16 v[32:35], v[160:163], v[16:19], v[32:35]
    v_perm_b32 v227, v157, v153, s49
    v_perm_b32 v231, v158, v154, s48
    v_mfma_f32_16x16x32_bf16 v[56:59], v[160:163], v[20:23], v[56:59]
    v_perm_b32 v235, v158, v154, s49
    v_mfma_f32_16x16x32_bf16 v[36:39], v[164:167], v[16:19], v[36:39]
    v_mfma_f32_16x16x32_bf16 v[60:63], v[164:167], v[20:23], v[60:63]
    v_mfma_f32_16x16x32_bf16 v[40:43], v[168:171], v[16:19], v[40:43]
    ds_write_b128 v220, v[56:59]
    v_mfma_f32_16x16x32_bf16 v[64:67], v[168:171], v[20:23], v[64:67]
    v_mfma_f32_16x16x32_bf16 v[44:47], v[224:227], v[16:19], v[44:47]
    ds_write_b128 v220, v[60:63] offset:1024
    v_mfma_f32_16x16x32_bf16 v[68:71], v[224:227], v[20:23], v[68:71]
    v_mfma_f32_16x16x32_bf16 v[48:51], v[228:231], v[16:19], v[48:51]
    ds_write_b128 v220, v[64:67] offset:2048
    v_mfma_f32_16x16x32_bf16 v[72:75], v[228:231], v[20:23], v[72:75]
    v_mfma_f32_16x16x32_bf16 v[52:55], v[232:235], v[16:19], v[52:55]
    ds_write_b128 v220, v[68:71] offset:3072
    v_mfma_f32_16x16x32_bf16 v[76:79], v[232:235], v[20:23], v[76:79]
    v_mfma_f32_16x16x32_bf16 v[80:83], v[160:163], v[24:27], v[80:83]
    ds_write_b128 v220, v[72:75] offset:4096
    v_mfma_f32_16x16x32_bf16 v[104:107], v[160:163], v[28:31], v[104:107]
    v_mfma_f32_16x16x32_bf16 v[84:87], v[164:167], v[24:27], v[84:87]
    ds_write_b128 v220, v[76:79] offset:5120
    s_mov_b64 exec, 1
    ds_write_b32 v13, v255
    s_mov_b64 exec, -1
    v_mfma_f32_16x16x32_bf16 v[108:111], v[164:167], v[28:31], v[108:111]
    ds_write_b128 v220, v[80:83] offset:6144
    v_mfma_f32_16x16x32_bf16 v[88:91], v[168:171], v[24:27], v[88:91]
    ds_write_b128 v220, v[104:107] offset:36864
    v_mfma_f32_16x16x32_bf16 v[112:115], v[168:171], v[28:31], v[112:115]
    ds_write_b128 v220, v[84:87] offset:7168
    v_mfma_f32_16x16x32_bf16 v[92:95], v[224:227], v[24:27], v[92:95]
    ds_write_b128 v220, v[108:111] offset:37888
    v_mfma_f32_16x16x32_bf16 v[116:119], v[224:227], v[28:31], v[116:119]
    ds_write_b128 v220, v[88:91] offset:32768
    v_mfma_f32_16x16x32_bf16 v[96:99], v[228:231], v[24:27], v[96:99]
    ds_write_b128 v220, v[112:115] offset:38912
    v_mfma_f32_16x16x32_bf16 v[120:123], v[228:231], v[28:31], v[120:123]
    ds_write_b128 v220, v[92:95] offset:33792
    v_mfma_f32_16x16x32_bf16 v[100:103], v[232:235], v[24:27], v[100:103]
    ds_write_b128 v220, v[116:119] offset:39936
    v_mfma_f32_16x16x32_bf16 v[124:127], v[232:235], v[28:31], v[124:127]
    ds_write_b128 v220, v[96:99] offset:34816
    s_nop 0
    ds_write_b128 v12, v[120:123]
    s_nop 1
    ds_write_b128 v220, v[100:103] offset:35840
    s_nop 1
    ds_write_b128 v12, v[124:127] offset:1024
    s_mov_b64 exec, 1
    ds_write_b32 v13, v251
    s_mov_b64 exec, -1
    s_branch L_PJ
L_LCK_3:
    s_waitcnt vmcnt(0)
    v_perm_b32 v163, v156, v152, s48
    v_perm_b32 v167, v156, v152, s49
    v_perm_b32 v171, v157, v153, s48
    s_waitcnt lgkmcnt(0)
    v_mfma_f32_16x16x32_bf16 v[80:83], v[160:163], v[24:27], v[80:83]
    v_perm_b32 v227, v157, v153, s49
    v_perm_b32 v231, v158, v154, s48
    v_mfma_f32_16x16x32_bf16 v[104:107], v[160:163], v[28:31], v[104:107]
    v_perm_b32 v235, v158, v154, s49
    v_mfma_f32_16x16x32_bf16 v[84:87], v[164:167], v[24:27], v[84:87]
    v_mfma_f32_16x16x32_bf16 v[108:111], v[164:167], v[28:31], v[108:111]
    ds_write_b128 v220, v[80:83] offset:6144
    v_mfma_f32_16x16x32_bf16 v[88:91], v[168:171], v[24:27], v[88:91]
    ds_write_b128 v220, v[104:107] offset:36864
    v_mfma_f32_16x16x32_bf16 v[112:115], v[168:171], v[28:31], v[112:115]
    ds_write_b128 v220, v[84:87] offset:7168
    v_mfma_f32_16x16x32_bf16 v[92:95], v[224:227], v[24:27], v[92:95]
    ds_write_b128 v220, v[108:111] offset:37888
    v_mfma_f32_16x16x32_bf16 v[116:119], v[224:227], v[28:31], v[116:119]
    ds_write_b128 v220, v[88:91] offset:32768
    v_mfma_f32_16x16x32_bf16 v[96:99], v[228:231], v[24:27], v[96:99]
    ds_write_b128 v220, v[112:115] offset:38912
    v_mfma_f32_16x16x32_bf16 v[120:123], v[228:231], v[28:31], v[120:123]
    ds_write_b128 v220, v[92:95] offset:33792
    v_mfma_f32_16x16x32_bf16 v[100:103], v[232:235], v[24:27], v[100:103]
    ds_write_b128 v220, v[116:119] offset:39936
    v_mfma_f32_16x16x32_bf16 v[124:127], v[232:235], v[28:31], v[124:127]
    ds_write_b128 v220, v[96:99] offset:34816
    v_mfma_f32_16x16x32_bf16 v[56:59], v[160:163], v[20:23], v[56:59]
    ds_write_b128 v12, v[120:123]
    v_mfma_f32_16x16x32_bf16 v[60:63], v[164:167], v[20:23], v[60:63]
    ds_write_b128 v220, v[100:103] offset:35840
    v_mfma_f32_16x16x32_bf16 v[64:67], v[168:171], v[20:23], v[64:67]
    ds_write_b128 v12, v[124:127] offset:1024
    s_mov_b64 exec, 1
    ds_write_b32 v13, v255
    s_mov_b64 exec, -1
    v_mfma_f32_16x16x32_bf16 v[68:71], v[224:227], v[20:23], v[68:71]
    ds_write_b128 v220, v[56:59]
    v_mfma_f32_16x16x32_bf16 v[72:75], v[228:231], v[20:23], v[72:75]
    ds_write_b128 v220, v[60:63] offset:1024
    v_mfma_f32_16x16x32_bf16 v[76:79], v[232:235], v[20:23], v[76:79]
    ds_write_b128 v220, v[64:67] offset:2048
    v_mfma_f32_16x16x32_bf16 v[32:35], v[160:163], v[16:19], v[32:35]
    ds_write_b128 v220, v[68:71] offset:3072
    v_mfma_f32_16x16x32_bf16 v[36:39], v[164:167], v[16:19], v[36:39]
    ds_write_b128 v220, v[72:75] offset:4096
    v_mfma_f32_16x16x32_bf16 v[40:43], v[168:171], v[16:19], v[40:43]
    ds_write_b128 v220, v[76:79] offset:5120
    s_mov_b64 exec, 1
    ds_write_b32 v13, v251
    s_mov_b64 exec, -1
    v_mfma_f32_16x16x32_bf16 v[44:47], v[224:227], v[16:19], v[44:47]
    v_mfma_f32_16x16x32_bf16 v[48:51], v[228:231], v[16:19], v[48:51]
    v_mfma_f32_16x16x32_bf16 v[52:55], v[232:235], v[16:19], v[52:55]
    s_nop 7
    s_branch L_PJ
L_PV:
    v_and_b32 v4, 15, v1
    v_lshrrev_b32 v5, 4, v1
    v_mul_u32_u24 v3, 3072, v5
    v_mad_u32_u24 v3, v4, 12, v3
    s_mul_i32 s64, s45, 786432
    s_and_b32 s53, s47, 1
    s_mul_i32 s52, s53, 393216
    s_add_u32 s64, s64, s52
    s_and_b32 s52, s47, 2
    s_mul_i32 s52, s52, 96
    s_add_u32 s64, s64, s52
    s_mul_i32 s52, s44, 24576
    s_add_u32 s64, s64, s52
    s_and_b32 s66, s45, 3
    s_mov_b32 s68, s66
    s_mul_i32 s50, s66, 98304
    s_add_u32 s50, s50, s64
    s_add_u32 s66, s66, 1
    s_and_b32 s66, s66, 3
    buffer_load_dwordx3 v[224:226], v3, s[24:27], s50 offen nt
    buffer_load_dwordx3 v[228:230], v3, s[24:27], s50 offen offset:384 nt
    buffer_load_dwordx3 v[232:234], v3, s[24:27], s50 offen offset:768 nt
    buffer_load_dwordx3 v[236:238], v3, s[24:27], s50 offen offset:1152 nt
    buffer_load_dwordx3 v[240:242], v3, s[24:27], s50 offen offset:1536 nt
    buffer_load_dwordx3 v[244:246], v3, s[24:27], s50 offen offset:1920 nt
    buffer_load_dwordx3 v[248:250], v3, s[24:27], s50 offen offset:2304 nt
    buffer_load_dwordx3 v[252:254], v3, s[24:27], s50 offen offset:2688 nt
    s_add_u32 s50, s50, 12288
    buffer_load_dwordx3 v[160:162], v3, s[24:27], s50 offen nt
    buffer_load_dwordx3 v[164:166], v3, s[24:27], s50 offen offset:384 nt
    buffer_load_dwordx3 v[168:170], v3, s[24:27], s50 offen offset:768 nt
    buffer_load_dwordx3 v[172:174], v3, s[24:27], s50 offen offset:1152 nt
    buffer_load_dwordx3 v[176:178], v3, s[24:27], s50 offen offset:1536 nt
    buffer_load_dwordx3 v[180:182], v3, s[24:27], s50 offen offset:1920 nt
    buffer_load_dwordx3 v[184:186], v3, s[24:27], s50 offen offset:2304 nt
    buffer_load_dwordx3 v[188:190], v3, s[24:27], s50 offen offset:2688 nt
    s_mul_i32 s50, s66, 98304
    s_add_u32 s50, s50, s64
    s_add_u32 s66, s66, 1
    s_and_b32 s66, s66, 3
    buffer_load_dwordx3 v[192:194], v3, s[24:27], s50 offen nt
    buffer_load_dwordx3 v[196:198], v3, s[24:27], s50 offen offset:384 nt
    buffer_load_dwordx3 v[200:202], v3, s[24:27], s50 offen offset:768 nt
    buffer_load_dwordx3 v[204:206], v3, s[24:27], s50 offen offset:1152 nt
    buffer_load_dwordx3 v[208:210], v3, s[24:27], s50 offen offset:1536 nt
    buffer_load_dwordx3 v[212:214], v3, s[24:27], s50 offen offset:1920 nt
    buffer_load_dwordx3 v[216:218], v3, s[24:27], s50 offen offset:2304 nt
    buffer_load_dwordx3 v[220:222], v3, s[24:27], s50 offen offset:2688 nt
    s_add_u32 s50, s50, 12288
    buffer_load_dwordx3 v[128:130], v3, s[24:27], s50 offen nt
    buffer_load_dwordx3 v[132:134], v3, s[24:27], s50 offen offset:384 nt
    buffer_load_dwordx3 v[136:138], v3, s[24:27], s50 offen offset:768 nt
    buffer_load_dwordx3 v[140:142], v3, s[24:27], s50 offen offset:1152 nt
    buffer_load_dwordx3 v[144:146], v3, s[24:27], s50 offen offset:1536 nt
    buffer_load_dwordx3 v[148:150], v3, s[24:27], s50 offen offset:1920 nt
    buffer_load_dwordx3 v[152:154], v3, s[24:27], s50 offen offset:2304 nt
    buffer_load_dwordx3 v[156:158], v3, s[24:27], s50 offen offset:2688 nt
    s_lshl_b32 s65, s44, 7
    s_and_b32 s53, s47, 1
    s_lshl_b32 s53, s53, 11
    s_add_u32 s65, s65, s53
    s_lshl_b32 s67, s44, 13
    v_and_b32 v6, 7, v1
    v_xor_b32 v6, v6, v5
    v_lshrrev_b32 v7, 3, v1
    v_lshlrev_b32 v7, 12, v7
    v_lshl_add_u32 v6, v6, 4, v7
    v_xor_b32 v7, 64, v6
    s_lshr_b32 s52, s44, 1
    s_lshl_b32 s52, s52, 17
    s_xor_b32 s53, s52, 0x0
    v_add_u32 v131, s53, v6
    s_xor_b32 s53, s52, 0x0
    s_add_u32 s53, s53, 0xfc00
    v_add_u32 v135, s53, v7
    s_xor_b32 s53, s52, 0x0
    s_add_u32 s53, s53, 0x7800
    v_add_u32 v139, s53, v6
    s_xor_b32 s53, s52, 0x0
    s_add_u32 s53, s53, 0x17400
    v_add_u32 v143, s53, v7
    s_xor_b32 s53, s52, 0x20000
    v_add_u32 v147, s53, v6
    s_xor_b32 s53, s52, 0x20000
    s_add_u32 s53, s53, 0xfc00
    v_add_u32 v151, s53, v7
    s_xor_b32 s53, s52, 0x20000
    s_add_u32 s53, s53, 0x7800
    v_add_u32 v155, s53, v6
    s_xor_b32 s53, s52, 0x20000
    s_add_u32 s53, s53, 0x17400
    v_add_u32 v159, s53, v7
    s_lshl_b32 s51, s68, 9
    s_add_u32 s51, s51, s65
    s_add_u32 s68, s68, 1
    s_and_b32 s68, s68, 3
    s_add_u32 m0, s67, 65536
    s_nop 0
    buffer_load_dwordx4 v131, s[28:31], s51 offen lds
    buffer_load_dwordx4 v135, s[28:31], s51 offen offset:1024 lds
    buffer_load_dwordx4 v139, s[28:31], s51 offen offset:2048 lds
    buffer_load_dwordx4 v143, s[28:31], s51 offen offset:3072 lds
    s_add_u32 m0, s67, 69632
    s_nop 0
    buffer_load_dwordx4 v147, s[28:31], s51 offen lds
    buffer_load_dwordx4 v151, s[28:31], s51 offen offset:1024 lds
    buffer_load_dwordx4 v155, s[28:31], s51 offen offset:2048 lds
    buffer_load_dwordx4 v159, s[28:31], s51 offen offset:3072 lds
    s_lshl_b32 s51, s68, 9
    s_add_u32 s51, s51, s65
    s_add_u32 s68, s68, 1
    s_and_b32 s68, s68, 3
    s_add_u32 m0, s67, 98304
    s_nop 0
    buffer_load_dwordx4 v131, s[28:31], s51 offen lds
    buffer_load_dwordx4 v135, s[28:31], s51 offen offset:1024 lds
    buffer_load_dwordx4 v139, s[28:31], s51 offen offset:2048 lds
    buffer_load_dwordx4 v143, s[28:31], s51 offen offset:3072 lds
    s_add_u32 m0, s67, 102400
    s_nop 0
    buffer_load_dwordx4 v147, s[28:31], s51 offen lds
    buffer_load_dwordx4 v151, s[28:31], s51 offen offset:1024 lds
    buffer_load_dwordx4 v155, s[28:31], s51 offen offset:2048 lds
    buffer_load_dwordx4 v159, s[28:31], s51 offen offset:3072 lds
    s_lshl_b32 s51, s68, 9
    s_add_u32 s51, s51, s65
    s_add_u32 s68, s68, 1
    s_and_b32 s68, s68, 3
    s_add_u32 m0, s67, 0
    s_nop 0
    buffer_load_dwordx4 v131, s[28:31], s51 offen lds
    buffer_load_dwordx4 v135, s[28:31], s51 offen offset:1024 lds
    buffer_load_dwordx4 v139, s[28:31], s51 offen offset:2048 lds
    buffer_load_dwordx4 v143, s[28:31], s51 offen offset:3072 lds
    s_add_u32 m0, s67, 4096
    s_nop 0
    buffer_load_dwordx4 v147, s[28:31], s51 offen lds
    buffer_load_dwordx4 v151, s[28:31], s51 offen offset:1024 lds
    buffer_load_dwordx4 v155, s[28:31], s51 offen offset:2048 lds
    buffer_load_dwordx4 v159, s[28:31], s51 offen offset:3072 lds
    v_lshrrev_b32 v6, 1, v4
    v_xor_b32 v6, v6, v5
    v_lshlrev_b32 v6, 4, v6
    v_lshl_add_u32 v6, v4, 7, v6
    v_add_u32 v163, s67, v6
    v_xor_b32 v167, 64, v163
    v_add_u32 v171, 0x10000, v163
    v_add_u32 v223, 0x10000, v167
    s_mov_b32 s48, 0x05040100
    s_mov_b32 s49, 0x07060302
    s_and_b32 s52, s44, 1
    s_cmp_eq_u32 s52, 1
    s_cselect_b32 s48, 0x07060302, s48
    s_cselect_b32 s49, 0x05040100, s49
    s_waitcnt vmcnt(48)
    s_lshl_b32 s51, s68, 9
    s_add_u32 s51, s51, s65
    s_add_u32 s68, s68, 1
    s_and_b32 s68, s68, 3
    s_add_u32 m0, s67, 32768
    s_nop 0
    buffer_load_dwordx4 v131, s[28:31], s51 offen lds
    buffer_load_dwordx4 v135, s[28:31], s51 offen offset:1024 lds
    buffer_load_dwordx4 v139, s[28:31], s51 offen offset:2048 lds
    buffer_load_dwordx4 v143, s[28:31], s51 offen offset:3072 lds
    s_add_u32 m0, s67, 36864
    s_nop 0
    buffer_load_dwordx4 v147, s[28:31], s51 offen lds
    buffer_load_dwordx4 v151, s[28:31], s51 offen offset:1024 lds
    buffer_load_dwordx4 v155, s[28:31], s51 offen offset:2048 lds
    buffer_load_dwordx4 v159, s[28:31], s51 offen offset:3072 lds
    s_waitcnt vmcnt(24)
    ds_read_b128 v[16:19], v171
    ds_read_b128 v[20:23], v171 offset:2048
    ds_read_b128 v[24:27], v171 offset:4096
    ds_read_b128 v[28:31], v171 offset:6144
    v_perm_b32 v4, v228, v224, s48
    v_perm_b32 v5, v236, v232, s48
    v_perm_b32 v6, v244, v240, s48
    v_perm_b32 v7, v252, v248, s48
    s_waitcnt lgkmcnt(0)
    s_nop 0
    v_mfma_f32_16x16x32_bf16 v[32:35], v[16:19], v[4:7], 0
    v_perm_b32 v8, v228, v224, s49
    v_perm_b32 v12, v229, v225, s48
    v_mfma_f32_16x16x32_bf16 v[36:39], v[20:23], v[4:7], 0
    v_perm_b32 v9, v236, v232, s49
    v_perm_b32 v13, v237, v233, s48
    v_mfma_f32_16x16x32_bf16 v[80:83], v[24:27], v[4:7], 0
    v_perm_b32 v10, v244, v240, s49
    v_perm_b32 v14, v245, v241, s48
    v_mfma_f32_16x16x32_bf16 v[84:87], v[28:31], v[4:7], 0
    v_perm_b32 v11, v252, v248, s49
    v_perm_b32 v15, v253, v249, s48
    s_nop 0
    v_mfma_f32_16x16x32_bf16 v[56:59], v[16:19], v[8:11], 0
    v_perm_b32 v4, v229, v225, s49
    v_mfma_f32_16x16x32_bf16 v[60:63], v[20:23], v[8:11], 0
    v_perm_b32 v5, v237, v233, s49
    v_mfma_f32_16x16x32_bf16 v[104:107], v[24:27], v[8:11], 0
    v_perm_b32 v6, v245, v241, s49
    v_mfma_f32_16x16x32_bf16 v[108:111], v[28:31], v[8:11], 0
    v_perm_b32 v7, v253, v249, s49
    v_mfma_f32_16x16x32_bf16 v[40:43], v[16:19], v[12:15], 0
    v_perm_b32 v8, v230, v226, s48
    v_mfma_f32_16x16x32_bf16 v[44:47], v[20:23], v[12:15], 0
    v_perm_b32 v9, v238, v234, s48
    v_mfma_f32_16x16x32_bf16 v[88:91], v[24:27], v[12:15], 0
    v_perm_b32 v10, v246, v242, s48
    v_mfma_f32_16x16x32_bf16 v[92:95], v[28:31], v[12:15], 0
    v_perm_b32 v11, v254, v250, s48
    v_mfma_f32_16x16x32_bf16 v[64:67], v[16:19], v[4:7], 0
    v_perm_b32 v12, v230, v226, s49
    v_mfma_f32_16x16x32_bf16 v[68:71], v[20:23], v[4:7], 0
    v_perm_b32 v13, v238, v234, s49
    v_mfma_f32_16x16x32_bf16 v[112:115], v[24:27], v[4:7], 0
    v_perm_b32 v14, v246, v242, s49
    v_mfma_f32_16x16x32_bf16 v[116:119], v[28:31], v[4:7], 0
    v_perm_b32 v15, v254, v250, s49
    s_mul_i32 s50, s66, 98304
    s_add_u32 s50, s50, s64
    s_add_u32 s66, s66, 1
    s_and_b32 s66, s66, 3
    buffer_load_dwordx3 v[224:226], v3, s[24:27], s50 offen nt
    buffer_load_dwordx3 v[228:230], v3, s[24:27], s50 offen offset:384 nt
    buffer_load_dwordx3 v[232:234], v3, s[24:27], s50 offen offset:768 nt
    buffer_load_dwordx3 v[236:238], v3, s[24:27], s50 offen offset:1152 nt
    buffer_load_dwordx3 v[240:242], v3, s[24:27], s50 offen offset:1536 nt
    buffer_load_dwordx3 v[244:246], v3, s[24:27], s50 offen offset:1920 nt
    buffer_load_dwordx3 v[248:250], v3, s[24:27], s50 offen offset:2304 nt
    buffer_load_dwordx3 v[252:254], v3, s[24:27], s50 offen offset:2688 nt
    v_mfma_f32_16x16x32_bf16 v[48:51], v[16:19], v[8:11], 0
    v_mfma_f32_16x16x32_bf16 v[52:55], v[20:23], v[8:11], 0
    v_mfma_f32_16x16x32_bf16 v[96:99], v[24:27], v[8:11], 0
    v_mfma_f32_16x16x32_bf16 v[100:103], v[28:31], v[8:11], 0
    v_mfma_f32_16x16x32_bf16 v[72:75], v[16:19], v[12:15], 0
    v_mfma_f32_16x16x32_bf16 v[76:79], v[20:23], v[12:15], 0
    v_mfma_f32_16x16x32_bf16 v[120:123], v[24:27], v[12:15], 0
    v_mfma_f32_16x16x32_bf16 v[124:127], v[28:31], v[12:15], 0
    ds_read_b128 v[16:19], v223
    ds_read_b128 v[20:23], v223 offset:2048
    ds_read_b128 v[24:27], v223 offset:4096
    ds_read_b128 v[28:31], v223 offset:6144
    v_perm_b32 v4, v164, v160, s48
    v_perm_b32 v5, v172, v168, s48
    v_perm_b32 v6, v180, v176, s48
    v_perm_b32 v7, v188, v184, s48
    s_waitcnt lgkmcnt(0)
    s_nop 0
    v_mfma_f32_16x16x32_bf16 v[32:35], v[16:19], v[4:7], v[32:35]
    v_perm_b32 v8, v164, v160, s49
    v_perm_b32 v12, v165, v161, s48
    v_mfma_f32_16x16x32_bf16 v[36:39], v[20:23], v[4:7], v[36:39]
    v_perm_b32 v9, v172, v168, s49
    v_perm_b32 v13, v173, v169, s48
    v_mfma_f32_16x16x32_bf16 v[80:83], v[24:27], v[4:7], v[80:83]
    v_perm_b32 v10, v180, v176, s49
    v_perm_b32 v14, v181, v177, s48
    v_mfma_f32_16x16x32_bf16 v[84:87], v[28:31], v[4:7], v[84:87]
    v_perm_b32 v11, v188, v184, s49
    v_perm_b32 v15, v189, v185, s48
    s_nop 0
    v_mfma_f32_16x16x32_bf16 v[56:59], v[16:19], v[8:11], v[56:59]
    v_perm_b32 v4, v165, v161, s49
    v_mfma_f32_16x16x32_bf16 v[60:63], v[20:23], v[8:11], v[60:63]
    v_perm_b32 v5, v173, v169, s49
    v_mfma_f32_16x16x32_bf16 v[104:107], v[24:27], v[8:11], v[104:107]
    v_perm_b32 v6, v181, v177, s49
    v_mfma_f32_16x16x32_bf16 v[108:111], v[28:31], v[8:11], v[108:111]
    v_perm_b32 v7, v189, v185, s49
    v_mfma_f32_16x16x32_bf16 v[40:43], v[16:19], v[12:15], v[40:43]
    v_perm_b32 v8, v166, v162, s48
    v_mfma_f32_16x16x32_bf16 v[44:47], v[20:23], v[12:15], v[44:47]
    v_perm_b32 v9, v174, v170, s48
    v_mfma_f32_16x16x32_bf16 v[88:91], v[24:27], v[12:15], v[88:91]
    v_perm_b32 v10, v182, v178, s48
    v_mfma_f32_16x16x32_bf16 v[92:95], v[28:31], v[12:15], v[92:95]
    v_perm_b32 v11, v190, v186, s48
    v_mfma_f32_16x16x32_bf16 v[64:67], v[16:19], v[4:7], v[64:67]
    v_perm_b32 v12, v166, v162, s49
    v_mfma_f32_16x16x32_bf16 v[68:71], v[20:23], v[4:7], v[68:71]
    v_perm_b32 v13, v174, v170, s49
    v_mfma_f32_16x16x32_bf16 v[112:115], v[24:27], v[4:7], v[112:115]
    v_perm_b32 v14, v182, v178, s49
    v_mfma_f32_16x16x32_bf16 v[116:119], v[28:31], v[4:7], v[116:119]
    v_perm_b32 v15, v190, v186, s49
    s_add_u32 s50, s50, 12288
    buffer_load_dwordx3 v[160:162], v3, s[24:27], s50 offen nt
    buffer_load_dwordx3 v[164:166], v3, s[24:27], s50 offen offset:384 nt
    buffer_load_dwordx3 v[168:170], v3, s[24:27], s50 offen offset:768 nt
    buffer_load_dwordx3 v[172:174], v3, s[24:27], s50 offen offset:1152 nt
    buffer_load_dwordx3 v[176:178], v3, s[24:27], s50 offen offset:1536 nt
    buffer_load_dwordx3 v[180:182], v3, s[24:27], s50 offen offset:1920 nt
    buffer_load_dwordx3 v[184:186], v3, s[24:27], s50 offen offset:2304 nt
    buffer_load_dwordx3 v[188:190], v3, s[24:27], s50 offen offset:2688 nt
    v_mfma_f32_16x16x32_bf16 v[48:51], v[16:19], v[8:11], v[48:51]
    v_mfma_f32_16x16x32_bf16 v[52:55], v[20:23], v[8:11], v[52:55]
    v_mfma_f32_16x16x32_bf16 v[96:99], v[24:27], v[8:11], v[96:99]
    v_mfma_f32_16x16x32_bf16 v[100:103], v[28:31], v[8:11], v[100:103]
    v_mfma_f32_16x16x32_bf16 v[72:75], v[16:19], v[12:15], v[72:75]
    v_mfma_f32_16x16x32_bf16 v[76:79], v[20:23], v[12:15], v[76:79]
    v_mfma_f32_16x16x32_bf16 v[120:123], v[24:27], v[12:15], v[120:123]
    v_mfma_f32_16x16x32_bf16 v[124:127], v[28:31], v[12:15], v[124:127]
    s_waitcnt vmcnt(32)
    ds_read_b128 v[16:19], v171 offset:32768
    ds_read_b128 v[20:23], v171 offset:34816
    ds_read_b128 v[24:27], v171 offset:36864
    ds_read_b128 v[28:31], v171 offset:38912
    v_perm_b32 v4, v196, v192, s48
    v_perm_b32 v5, v204, v200, s48
    v_perm_b32 v6, v212, v208, s48
    v_perm_b32 v7, v220, v216, s48
    s_waitcnt lgkmcnt(0)
    s_mov_b64 exec, 1
    ds_max_u32 v251, v251 offset:36
    s_mov_b64 exec, -1
    v_mfma_f32_16x16x32_bf16 v[32:35], v[16:19], v[4:7], v[32:35]
    v_perm_b32 v8, v196, v192, s49
    v_perm_b32 v12, v197, v193, s48
    v_mfma_f32_16x16x32_bf16 v[36:39], v[20:23], v[4:7], v[36:39]
    v_perm_b32 v9, v204, v200, s49
    v_perm_b32 v13, v205, v201, s48
    v_mfma_f32_16x16x32_bf16 v[80:83], v[24:27], v[4:7], v[80:83]
    v_perm_b32 v10, v212, v208, s49
    v_perm_b32 v14, v213, v209, s48
    v_mfma_f32_16x16x32_bf16 v[84:87], v[28:31], v[4:7], v[84:87]
    v_perm_b32 v11, v220, v216, s49
    v_perm_b32 v15, v221, v217, s48
    s_nop 0
    v_mfma_f32_16x16x32_bf16 v[56:59], v[16:19], v[8:11], v[56:59]
    v_perm_b32 v4, v197, v193, s49
    v_mfma_f32_16x16x32_bf16 v[60:63], v[20:23], v[8:11], v[60:63]
    v_perm_b32 v5, v205, v201, s49
    v_mfma_f32_16x16x32_bf16 v[104:107], v[24:27], v[8:11], v[104:107]
    v_perm_b32 v6, v213, v209, s49
    v_mfma_f32_16x16x32_bf16 v[108:111], v[28:31], v[8:11], v[108:111]
    v_perm_b32 v7, v221, v217, s49
    v_mfma_f32_16x16x32_bf16 v[40:43], v[16:19], v[12:15], v[40:43]
    v_perm_b32 v8, v198, v194, s48
    v_mfma_f32_16x16x32_bf16 v[44:47], v[20:23], v[12:15], v[44:47]
    v_perm_b32 v9, v206, v202, s48
    v_mfma_f32_16x16x32_bf16 v[88:91], v[24:27], v[12:15], v[88:91]
    v_perm_b32 v10, v214, v210, s48
    v_mfma_f32_16x16x32_bf16 v[92:95], v[28:31], v[12:15], v[92:95]
    v_perm_b32 v11, v222, v218, s48
    v_mfma_f32_16x16x32_bf16 v[64:67], v[16:19], v[4:7], v[64:67]
    v_perm_b32 v12, v198, v194, s49
    v_mfma_f32_16x16x32_bf16 v[68:71], v[20:23], v[4:7], v[68:71]
    v_perm_b32 v13, v206, v202, s49
    v_mfma_f32_16x16x32_bf16 v[112:115], v[24:27], v[4:7], v[112:115]
    v_perm_b32 v14, v214, v210, s49
    v_mfma_f32_16x16x32_bf16 v[116:119], v[28:31], v[4:7], v[116:119]
    v_perm_b32 v15, v222, v218, s49
    s_mul_i32 s50, s66, 98304
    s_add_u32 s50, s50, s64
    s_add_u32 s66, s66, 1
    s_and_b32 s66, s66, 3
    buffer_load_dwordx3 v[192:194], v3, s[24:27], s50 offen nt
    buffer_load_dwordx3 v[196:198], v3, s[24:27], s50 offen offset:384 nt
    buffer_load_dwordx3 v[200:202], v3, s[24:27], s50 offen offset:768 nt
    buffer_load_dwordx3 v[204:206], v3, s[24:27], s50 offen offset:1152 nt
    buffer_load_dwordx3 v[208:210], v3, s[24:27], s50 offen offset:1536 nt
    buffer_load_dwordx3 v[212:214], v3, s[24:27], s50 offen offset:1920 nt
    buffer_load_dwordx3 v[216:218], v3, s[24:27], s50 offen offset:2304 nt
    buffer_load_dwordx3 v[220:222], v3, s[24:27], s50 offen offset:2688 nt
    v_mfma_f32_16x16x32_bf16 v[48:51], v[16:19], v[8:11], v[48:51]
    v_mfma_f32_16x16x32_bf16 v[52:55], v[20:23], v[8:11], v[52:55]
    v_mfma_f32_16x16x32_bf16 v[96:99], v[24:27], v[8:11], v[96:99]
    v_mfma_f32_16x16x32_bf16 v[100:103], v[28:31], v[8:11], v[100:103]
    v_mfma_f32_16x16x32_bf16 v[72:75], v[16:19], v[12:15], v[72:75]
    v_mfma_f32_16x16x32_bf16 v[76:79], v[20:23], v[12:15], v[76:79]
    v_mfma_f32_16x16x32_bf16 v[120:123], v[24:27], v[12:15], v[120:123]
    v_mfma_f32_16x16x32_bf16 v[124:127], v[28:31], v[12:15], v[124:127]
    ds_read_b128 v[16:19], v223 offset:32768
    ds_read_b128 v[20:23], v223 offset:34816
    ds_read_b128 v[24:27], v223 offset:36864
    ds_read_b128 v[28:31], v223 offset:38912
    v_perm_b32 v4, v132, v128, s48
    v_perm_b32 v5, v140, v136, s48
    v_perm_b32 v6, v148, v144, s48
    v_perm_b32 v7, v156, v152, s48
    s_waitcnt lgkmcnt(0)
    s_nop 0
    v_mfma_f32_16x16x32_bf16 v[32:35], v[16:19], v[4:7], v[32:35]
    v_perm_b32 v8, v132, v128, s49
    v_perm_b32 v12, v133, v129, s48
    v_mfma_f32_16x16x32_bf16 v[36:39], v[20:23], v[4:7], v[36:39]
    v_perm_b32 v9, v140, v136, s49
    v_perm_b32 v13, v141, v137, s48
    v_mfma_f32_16x16x32_bf16 v[80:83], v[24:27], v[4:7], v[80:83]
    v_perm_b32 v10, v148, v144, s49
    v_perm_b32 v14, v149, v145, s48
    v_mfma_f32_16x16x32_bf16 v[84:87], v[28:31], v[4:7], v[84:87]
    v_perm_b32 v11, v156, v152, s49
    v_perm_b32 v15, v157, v153, s48
    s_nop 0
    v_mfma_f32_16x16x32_bf16 v[56:59], v[16:19], v[8:11], v[56:59]
    v_perm_b32 v4, v133, v129, s49
    v_mfma_f32_16x16x32_bf16 v[60:63], v[20:23], v[8:11], v[60:63]
    v_perm_b32 v5, v141, v137, s49
    v_mfma_f32_16x16x32_bf16 v[104:107], v[24:27], v[8:11], v[104:107]
    v_perm_b32 v6, v149, v145, s49
    v_mfma_f32_16x16x32_bf16 v[108:111], v[28:31], v[8:11], v[108:111]
    v_perm_b32 v7, v157, v153, s49
    v_mfma_f32_16x16x32_bf16 v[40:43], v[16:19], v[12:15], v[40:43]
    v_perm_b32 v8, v134, v130, s48
    v_mfma_f32_16x16x32_bf16 v[44:47], v[20:23], v[12:15], v[44:47]
    v_perm_b32 v9, v142, v138, s48
    v_mfma_f32_16x16x32_bf16 v[88:91], v[24:27], v[12:15], v[88:91]
    v_perm_b32 v10, v150, v146, s48
    v_mfma_f32_16x16x32_bf16 v[92:95], v[28:31], v[12:15], v[92:95]
    v_perm_b32 v11, v158, v154, s48
    v_mfma_f32_16x16x32_bf16 v[64:67], v[16:19], v[4:7], v[64:67]
    v_perm_b32 v12, v134, v130, s49
    v_mfma_f32_16x16x32_bf16 v[68:71], v[20:23], v[4:7], v[68:71]
    v_perm_b32 v13, v142, v138, s49
    v_mfma_f32_16x16x32_bf16 v[112:115], v[24:27], v[4:7], v[112:115]
    v_perm_b32 v14, v150, v146, s49
    v_mfma_f32_16x16x32_bf16 v[116:119], v[28:31], v[4:7], v[116:119]
    v_perm_b32 v15, v158, v154, s49
    s_add_u32 s50, s50, 12288
    buffer_load_dwordx3 v[128:130], v3, s[24:27], s50 offen nt
    buffer_load_dwordx3 v[132:134], v3, s[24:27], s50 offen offset:384 nt
    buffer_load_dwordx3 v[136:138], v3, s[24:27], s50 offen offset:768 nt
    buffer_load_dwordx3 v[140:142], v3, s[24:27], s50 offen offset:1152 nt
    buffer_load_dwordx3 v[144:146], v3, s[24:27], s50 offen offset:1536 nt
    buffer_load_dwordx3 v[148:150], v3, s[24:27], s50 offen offset:1920 nt
    buffer_load_dwordx3 v[152:154], v3, s[24:27], s50 offen offset:2304 nt
    buffer_load_dwordx3 v[156:158], v3, s[24:27], s50 offen offset:2688 nt
    v_mfma_f32_16x16x32_bf16 v[48:51], v[16:19], v[8:11], v[48:51]
    v_mfma_f32_16x16x32_bf16 v[52:55], v[20:23], v[8:11], v[52:55]
    v_mfma_f32_16x16x32_bf16 v[96:99], v[24:27], v[8:11], v[96:99]
    v_mfma_f32_16x16x32_bf16 v[100:103], v[28:31], v[8:11], v[100:103]
    v_mfma_f32_16x16x32_bf16 v[72:75], v[16:19], v[12:15], v[72:75]
    v_mfma_f32_16x16x32_bf16 v[76:79], v[20:23], v[12:15], v[76:79]
    v_mfma_f32_16x16x32_bf16 v[120:123], v[24:27], v[12:15], v[120:123]
    v_mfma_f32_16x16x32_bf16 v[124:127], v[28:31], v[12:15], v[124:127]
    s_waitcnt vmcnt(40)
    ds_read_b128 v[16:19], v163
    ds_read_b128 v[20:23], v163 offset:2048
    ds_read_b128 v[24:27], v163 offset:4096
    ds_read_b128 v[28:31], v163 offset:6144
    s_waitcnt vmcnt(24)
    v_perm_b32 v4, v228, v224, s48
    v_perm_b32 v5, v236, v232, s48
    v_perm_b32 v6, v244, v240, s48
    v_perm_b32 v7, v252, v248, s48
    s_waitcnt lgkmcnt(0)
    s_nop 0
    v_mfma_f32_16x16x32_bf16 v[32:35], v[16:19], v[4:7], v[32:35]
    v_perm_b32 v8, v228, v224, s49
    v_perm_b32 v12, v229, v225, s48
    v_mfma_f32_16x16x32_bf16 v[36:39], v[20:23], v[4:7], v[36:39]
    v_perm_b32 v9, v236, v232, s49
    v_perm_b32 v13, v237, v233, s48
    v_mfma_f32_16x16x32_bf16 v[80:83], v[24:27], v[4:7], v[80:83]
    v_perm_b32 v10, v244, v240, s49
    v_perm_b32 v14, v245, v241, s48
    v_mfma_f32_16x16x32_bf16 v[84:87], v[28:31], v[4:7], v[84:87]
    v_perm_b32 v11, v252, v248, s49
    v_perm_b32 v15, v253, v249, s48
    s_nop 0
    v_mfma_f32_16x16x32_bf16 v[56:59], v[16:19], v[8:11], v[56:59]
    v_perm_b32 v4, v229, v225, s49
    v_mfma_f32_16x16x32_bf16 v[60:63], v[20:23], v[8:11], v[60:63]
    v_perm_b32 v5, v237, v233, s49
    v_mfma_f32_16x16x32_bf16 v[104:107], v[24:27], v[8:11], v[104:107]
    v_perm_b32 v6, v245, v241, s49
    v_mfma_f32_16x16x32_bf16 v[108:111], v[28:31], v[8:11], v[108:111]
    v_perm_b32 v7, v253, v249, s49
    v_mfma_f32_16x16x32_bf16 v[40:43], v[16:19], v[12:15], v[40:43]
    v_perm_b32 v8, v230, v226, s48
    v_mfma_f32_16x16x32_bf16 v[44:47], v[20:23], v[12:15], v[44:47]
    v_perm_b32 v9, v238, v234, s48
    v_mfma_f32_16x16x32_bf16 v[88:91], v[24:27], v[12:15], v[88:91]
    v_perm_b32 v10, v246, v242, s48
    v_mfma_f32_16x16x32_bf16 v[92:95], v[28:31], v[12:15], v[92:95]
    v_perm_b32 v11, v254, v250, s48
    v_mfma_f32_16x16x32_bf16 v[64:67], v[16:19], v[4:7], v[64:67]
    v_perm_b32 v12, v230, v226, s49
    v_mfma_f32_16x16x32_bf16 v[68:71], v[20:23], v[4:7], v[68:71]
    v_perm_b32 v13, v238, v234, s49
    v_mfma_f32_16x16x32_bf16 v[112:115], v[24:27], v[4:7], v[112:115]
    v_perm_b32 v14, v246, v242, s49
    v_mfma_f32_16x16x32_bf16 v[116:119], v[28:31], v[4:7], v[116:119]
    v_perm_b32 v15, v254, v250, s49
    v_mfma_f32_16x16x32_bf16 v[48:51], v[16:19], v[8:11], v[48:51]
    v_mfma_f32_16x16x32_bf16 v[52:55], v[20:23], v[8:11], v[52:55]
    v_mfma_f32_16x16x32_bf16 v[96:99], v[24:27], v[8:11], v[96:99]
    v_mfma_f32_16x16x32_bf16 v[100:103], v[28:31], v[8:11], v[100:103]
    v_mfma_f32_16x16x32_bf16 v[72:75], v[16:19], v[12:15], v[72:75]
    v_mfma_f32_16x16x32_bf16 v[76:79], v[20:23], v[12:15], v[76:79]
    v_mfma_f32_16x16x32_bf16 v[120:123], v[24:27], v[12:15], v[120:123]
    v_mfma_f32_16x16x32_bf16 v[124:127], v[28:31], v[12:15], v[124:127]
    s_mov_b32 s20, s4
    s_mov_b32 s21, s5
    s_mov_b32 s22, 0x1800000
    s_mov_b32 s23, 0x00020000
    s_mov_b32 s32, s14
    s_mov_b32 s33, s15
    s_mov_b32 s34, 0x1800000
    s_mov_b32 s35, 0x00020000
    s_mov_b32 s36, s18
    s_mov_b32 s37, s19
    s_mov_b32 s38, 0x1a0000
    s_mov_b32 s39, 0x00020000
    v_lshrrev_b32 v224, 3, v1
    v_and_b32 v225, 7, v1
    v_mul_u32_u24 v236, 384, v224
    v_lshl_add_u32 v236, v225, 4, v236
    s_lshl_b32 s52, s44, 13
    s_add_u32 s52, s52, 133120
    v_lshrrev_b32 v226, 4, v1
    v_xor_b32 v226, v226, v225
    v_lshlrev_b32 v226, 4, v226
    v_lshl_add_u32 v226, v224, 7, v226
    v_add_u32 v237, s52, v226
    v_xor_b32 v238, 64, v237
    v_and_b32 v224, 31, v1
    v_lshrrev_b32 v225, 5, v1
    v_bfe_u32 v226, v1, 1, 3
    v_xor_b32 v226, v226, v225
    v_lshlrev_b32 v226, 4, v226
    v_lshl_add_u32 v226, v224, 7, v226
    v_add_u32 v239, s52, v226
    v_xor_b32 v240, 32, v239
    v_xor_b32 v241, 64, v239
    v_xor_b32 v242, 96, v239
    v_mul_u32_u24 v243, 12, v224
    v_mul_u32_u24 v226, 1536, v225
    v_add_u32 v243, v243, v226
    v_lshlrev_b32 v244, 4, v1
    v_add_u32 v245, 0x10000, v244
    v_lshlrev_b32 v249, 2, v1
    s_lshl_b32 s52, s47, 3
    s_add_u32 s52, s52, s44
    s_mul_i32 s52, s52, 12288
    s_mul_i32 s56, s45, 786432
    s_add_u32 s56, s56, s52
    s_add_u32 s57, s56, 3072
    s_add_u32 s58, s56, 6144
    s_add_u32 s59, s56, 9216
    s_lshr_b32 s52, s44, 1
    s_xor_b32 s52, s52, s47
    s_and_b32 s69, s52, 1
    v_and_b32 v224, 15, v1
    v_lshrrev_b32 v225, 4, v1
    s_bfe_u32 s52, s44, 0x10001
    s_and_b32 s53, s44, 1
    s_mul_i32 s54, s52, 12288
    s_lshl_b32 s55, s53, 8
    s_add_u32 s54, s54, s55
    s_add_u32 s54, s54, 65536
    v_mul_u32_u24 v226, 1536, v225
    v_lshl_add_u32 v226, v224, 4, v226
    v_add_u32 v246, s54, v226
    s_lshl_b32 s54, s52, 11
    s_lshl_b32 s55, s53, 12
    s_add_u32 s54, s54, s55
    s_add_u32 s54, s54, 90112
    v_lshlrev_b32 v226, 9, v225
    v_lshl_add_u32 v226, v224, 4, v226
    v_add_u32 v247, s54, v226
    s_mul_i32 s60, s45, 53248
    s_xor_b32 s54, s69, s47
    s_mul_i32 s54, s54, 6656
    s_mul_i32 s55, s53, 3328
    s_add_u32 s71, s60, s54
    s_add_u32 s71, s71, s55
    s_add_u32 s72, s71, 4096
    s_mul_i32 s54, s47, 6656
    s_bfe_u32 s52, s47, 0x10001
    s_mul_i32 s55, s52, 6144
    v_add_u32 v246, s55, v246
    s_lshl_b32 s55, s52, 8
    v_add_u32 v247, s55, v247
    s_add_u32 s60, s60, s54
    s_mul_i32 s55, s53, 3328
    s_add_u32 s60, s60, s55
    ds_read_b128 v[16:19], v167
    ds_read_b128 v[20:23], v167 offset:2048
    ds_read_b128 v[24:27], v167 offset:4096
    ds_read_b128 v[28:31], v167 offset:6144
    s_waitcnt vmcnt(16)
    v_perm_b32 v4, v164, v160, s48
    v_perm_b32 v5, v172, v168, s48
    v_perm_b32 v6, v180, v176, s48
    v_perm_b32 v7, v188, v184, s48
    s_waitcnt lgkmcnt(0)
    s_nop 0
    v_mfma_f32_16x16x32_bf16 v[32:35], v[16:19], v[4:7], v[32:35]
    v_perm_b32 v8, v164, v160, s49
    v_perm_b32 v12, v165, v161, s48
    v_mfma_f32_16x16x32_bf16 v[36:39], v[20:23], v[4:7], v[36:39]
    v_perm_b32 v9, v172, v168, s49
    v_perm_b32 v13, v173, v169, s48
    v_mfma_f32_16x16x32_bf16 v[80:83], v[24:27], v[4:7], v[80:83]
    v_perm_b32 v10, v180, v176, s49
    v_perm_b32 v14, v181, v177, s48
    v_mfma_f32_16x16x32_bf16 v[84:87], v[28:31], v[4:7], v[84:87]
    v_perm_b32 v11, v188, v184, s49
    v_perm_b32 v15, v189, v185, s48
    s_nop 0
    v_mfma_f32_16x16x32_bf16 v[56:59], v[16:19], v[8:11], v[56:59]
    v_perm_b32 v4, v165, v161, s49
    v_mfma_f32_16x16x32_bf16 v[60:63], v[20:23], v[8:11], v[60:63]
    v_perm_b32 v5, v173, v169, s49
    v_mfma_f32_16x16x32_bf16 v[104:107], v[24:27], v[8:11], v[104:107]
    v_perm_b32 v6, v181, v177, s49
    v_mfma_f32_16x16x32_bf16 v[108:111], v[28:31], v[8:11], v[108:111]
    v_perm_b32 v7, v189, v185, s49
    v_mfma_f32_16x16x32_bf16 v[40:43], v[16:19], v[12:15], v[40:43]
    v_perm_b32 v8, v166, v162, s48
    v_mfma_f32_16x16x32_bf16 v[44:47], v[20:23], v[12:15], v[44:47]
    v_perm_b32 v9, v174, v170, s48
    v_mfma_f32_16x16x32_bf16 v[88:91], v[24:27], v[12:15], v[88:91]
    v_perm_b32 v10, v182, v178, s48
    v_mfma_f32_16x16x32_bf16 v[92:95], v[28:31], v[12:15], v[92:95]
    v_perm_b32 v11, v190, v186, s48
    v_mfma_f32_16x16x32_bf16 v[64:67], v[16:19], v[4:7], v[64:67]
    v_perm_b32 v12, v166, v162, s49
    v_mfma_f32_16x16x32_bf16 v[68:71], v[20:23], v[4:7], v[68:71]
    v_perm_b32 v13, v174, v170, s49
    v_mfma_f32_16x16x32_bf16 v[112:115], v[24:27], v[4:7], v[112:115]
    v_perm_b32 v14, v182, v178, s49
    v_mfma_f32_16x16x32_bf16 v[116:119], v[28:31], v[4:7], v[116:119]
    v_perm_b32 v15, v190, v186, s49
    s_mov_b64 exec, 1
    ds_add_u32 v251, v255 offset:32
    s_mov_b64 exec, -1
    v_mfma_f32_16x16x32_bf16 v[48:51], v[16:19], v[8:11], v[48:51]
    v_mfma_f32_16x16x32_bf16 v[52:55], v[20:23], v[8:11], v[52:55]
    v_mfma_f32_16x16x32_bf16 v[96:99], v[24:27], v[8:11], v[96:99]
    v_mfma_f32_16x16x32_bf16 v[100:103], v[28:31], v[8:11], v[100:103]
    v_mfma_f32_16x16x32_bf16 v[72:75], v[16:19], v[12:15], v[72:75]
    v_mfma_f32_16x16x32_bf16 v[76:79], v[20:23], v[12:15], v[76:79]
    v_mfma_f32_16x16x32_bf16 v[120:123], v[24:27], v[12:15], v[120:123]
    v_mfma_f32_16x16x32_bf16 v[124:127], v[28:31], v[12:15], v[124:127]
    ds_read_b128 v[16:19], v163 offset:32768
    ds_read_b128 v[20:23], v163 offset:34816
    ds_read_b128 v[24:27], v163 offset:36864
    ds_read_b128 v[28:31], v163 offset:38912
    s_waitcnt vmcnt(8)
    v_perm_b32 v4, v196, v192, s48
    v_perm_b32 v5, v204, v200, s48
    v_perm_b32 v6, v212, v208, s48
    v_perm_b32 v7, v220, v216, s48
    s_waitcnt lgkmcnt(0)
    s_nop 0
    v_mfma_f32_16x16x32_bf16 v[32:35], v[16:19], v[4:7], v[32:35]
    v_perm_b32 v8, v196, v192, s49
    v_perm_b32 v12, v197, v193, s48
    v_mfma_f32_16x16x32_bf16 v[36:39], v[20:23], v[4:7], v[36:39]
    v_perm_b32 v9, v204, v200, s49
    v_perm_b32 v13, v205, v201, s48
    v_mfma_f32_16x16x32_bf16 v[80:83], v[24:27], v[4:7], v[80:83]
    v_perm_b32 v10, v212, v208, s49
    v_perm_b32 v14, v213, v209, s48
    v_mfma_f32_16x16x32_bf16 v[84:87], v[28:31], v[4:7], v[84:87]
    v_perm_b32 v11, v220, v216, s49
    v_perm_b32 v15, v221, v217, s48
    s_nop 0
    v_mfma_f32_16x16x32_bf16 v[56:59], v[16:19], v[8:11], v[56:59]
    v_perm_b32 v4, v197, v193, s49
    v_mfma_f32_16x16x32_bf16 v[60:63], v[20:23], v[8:11], v[60:63]
    v_perm_b32 v5, v205, v201, s49
    v_mfma_f32_16x16x32_bf16 v[104:107], v[24:27], v[8:11], v[104:107]
    v_perm_b32 v6, v213, v209, s49
    v_mfma_f32_16x16x32_bf16 v[108:111], v[28:31], v[8:11], v[108:111]
    v_perm_b32 v7, v221, v217, s49
    v_mfma_f32_16x16x32_bf16 v[40:43], v[16:19], v[12:15], v[40:43]
    v_perm_b32 v8, v198, v194, s48
    v_mfma_f32_16x16x32_bf16 v[44:47], v[20:23], v[12:15], v[44:47]
    v_perm_b32 v9, v206, v202, s48
    v_mfma_f32_16x16x32_bf16 v[88:91], v[24:27], v[12:15], v[88:91]
    v_perm_b32 v10, v214, v210, s48
    v_mfma_f32_16x16x32_bf16 v[92:95], v[28:31], v[12:15], v[92:95]
    v_perm_b32 v11, v222, v218, s48
    v_mfma_f32_16x16x32_bf16 v[64:67], v[16:19], v[4:7], v[64:67]
    v_perm_b32 v12, v198, v194, s49
    v_mfma_f32_16x16x32_bf16 v[68:71], v[20:23], v[4:7], v[68:71]
    v_perm_b32 v13, v206, v202, s49
    v_mfma_f32_16x16x32_bf16 v[112:115], v[24:27], v[4:7], v[112:115]
    v_perm_b32 v14, v214, v210, s49
    v_mfma_f32_16x16x32_bf16 v[116:119], v[28:31], v[4:7], v[116:119]
    v_perm_b32 v15, v222, v218, s49
    v_mfma_f32_16x16x32_bf16 v[48:51], v[16:19], v[8:11], v[48:51]
    v_mfma_f32_16x16x32_bf16 v[52:55], v[20:23], v[8:11], v[52:55]
    v_mfma_f32_16x16x32_bf16 v[96:99], v[24:27], v[8:11], v[96:99]
    v_mfma_f32_16x16x32_bf16 v[100:103], v[28:31], v[8:11], v[100:103]
    v_mfma_f32_16x16x32_bf16 v[72:75], v[16:19], v[12:15], v[72:75]
    v_mfma_f32_16x16x32_bf16 v[76:79], v[20:23], v[12:15], v[76:79]
    v_mfma_f32_16x16x32_bf16 v[120:123], v[24:27], v[12:15], v[120:123]
    v_mfma_f32_16x16x32_bf16 v[124:127], v[28:31], v[12:15], v[124:127]
    s_nop 7
L_LP_4:
    ds_read_b32 v9, v251 offset:16
    s_waitcnt lgkmcnt(0)
    v_cmp_gt_u32 vcc, 1, v9
    s_cbranch_vccnz L_LP_4
    v_readfirstlane_b32 s46, v9
    ds_read_b32 v248, v251 offset:72
    ds_read_b128 v[16:19], v167 offset:32768
    ds_read_b128 v[20:23], v167 offset:34816
    ds_read_b128 v[24:27], v167 offset:36864
    ds_read_b128 v[28:31], v167 offset:38912
    v_add_u32 v220, s67, v244
    v_add_u32 v12, 0x20000, v220
    s_lshl_b32 s52, s44, 2
    v_add_u32 v13, s52, v251
    s_xor_b32 s53, s67, 8192
    v_add_u32 v221, s53, v244
    s_xor_b32 s53, s67, 16384
    v_add_u32 v222, s53, v244
    s_xor_b32 s53, s67, 24576
    v_add_u32 v223, s53, v244
    v_add_u32 v14, 0x20000, v223
    s_and_b32 s55, s45, 3
    s_bitcmp1_b32 10, s55
    s_cselect_b32 s77, 1, 0
    v_and_b32 v10, 3, v1
    v_lshl_add_u32 v10, v10, 2, v251
    s_mov_b32 s70, 0x7f800000
    v_mov_b32 v6, 0x7800000
    s_sub_u32 s73, 2, s69
    s_waitcnt vmcnt(6)
    v_perm_b32 v160, v132, v128, s48
    v_perm_b32 v164, v132, v128, s49
    v_perm_b32 v168, v133, v129, s48
    v_perm_b32 v224, v133, v129, s49
    v_perm_b32 v228, v134, v130, s48
    v_perm_b32 v232, v134, v130, s49
    s_waitcnt vmcnt(4)
    v_perm_b32 v161, v140, v136, s48
    v_perm_b32 v165, v140, v136, s49
    v_perm_b32 v169, v141, v137, s48
    v_perm_b32 v225, v141, v137, s49
    v_perm_b32 v229, v142, v138, s48
    v_perm_b32 v233, v142, v138, s49
    s_waitcnt vmcnt(2)
    v_perm_b32 v162, v148, v144, s48
    v_perm_b32 v166, v148, v144, s49
    v_perm_b32 v170, v149, v145, s48
    v_perm_b32 v226, v149, v145, s49
    v_perm_b32 v230, v150, v146, s48
    v_perm_b32 v234, v150, v146, s49
    s_cmp_eq_u32 s69, 0
    s_nop 0
    s_cbranch_scc1 L_LCK_6
    s_waitcnt vmcnt(0)
    v_perm_b32 v163, v156, v152, s48
    v_perm_b32 v167, v156, v152, s49
    v_perm_b32 v171, v157, v153, s48
    s_waitcnt lgkmcnt(0)
    v_mfma_f32_16x16x32_bf16 v[32:35], v[16:19], v[160:163], v[32:35]
    v_perm_b32 v227, v157, v153, s49
    v_perm_b32 v231, v158, v154, s48
    v_mfma_f32_16x16x32_bf16 v[36:39], v[20:23], v[160:163], v[36:39]
    v_perm_b32 v235, v158, v154, s49
    v_mfma_f32_16x16x32_bf16 v[56:59], v[16:19], v[164:167], v[56:59]
    v_mfma_f32_16x16x32_bf16 v[60:63], v[20:23], v[164:167], v[60:63]
    v_mfma_f32_16x16x32_bf16 v[40:43], v[16:19], v[168:171], v[40:43]
    v_mfma_f32_16x16x32_bf16 v[44:47], v[20:23], v[168:171], v[44:47]
    ds_write_b128 v220, v[56:59]
    v_mfma_f32_16x16x32_bf16 v[64:67], v[16:19], v[224:227], v[64:67]
    ds_write_b128 v220, v[60:63] offset:1024
    v_mfma_f32_16x16x32_bf16 v[68:71], v[20:23], v[224:227], v[68:71]
    v_mfma_f32_16x16x32_bf16 v[48:51], v[16:19], v[228:231], v[48:51]
    v_mfma_f32_16x16x32_bf16 v[52:55], v[20:23], v[228:231], v[52:55]
    ds_write_b128 v220, v[64:67] offset:2048
    v_mfma_f32_16x16x32_bf16 v[72:75], v[16:19], v[232:235], v[72:75]
    ds_write_b128 v220, v[68:71] offset:3072
    v_mfma_f32_16x16x32_bf16 v[76:79], v[20:23], v[232:235], v[76:79]
    v_mfma_f32_16x16x32_bf16 v[80:83], v[24:27], v[160:163], v[80:83]
    v_mfma_f32_16x16x32_bf16 v[84:87], v[28:31], v[160:163], v[84:87]
    ds_write_b128 v220, v[72:75] offset:4096
    v_mfma_f32_16x16x32_bf16 v[104:107], v[24:27], v[164:167], v[104:107]
    ds_write_b128 v220, v[76:79] offset:5120
    s_mov_b64 exec, 1
    ds_write_b32 v13, v255
    s_mov_b64 exec, -1
    v_mfma_f32_16x16x32_bf16 v[108:111], v[28:31], v[164:167], v[108:111]
    ds_write_b128 v220, v[80:83] offset:6144
    v_mfma_f32_16x16x32_bf16 v[88:91], v[24:27], v[168:171], v[88:91]
    ds_write_b128 v220, v[84:87] offset:7168
    v_mfma_f32_16x16x32_bf16 v[92:95], v[28:31], v[168:171], v[92:95]
    ds_write_b128 v220, v[104:107] offset:36864
    v_mfma_f32_16x16x32_bf16 v[112:115], v[24:27], v[224:227], v[112:115]
    ds_write_b128 v220, v[108:111] offset:37888
    v_mfma_f32_16x16x32_bf16 v[116:119], v[28:31], v[224:227], v[116:119]
    ds_write_b128 v220, v[88:91] offset:32768
    v_mfma_f32_16x16x32_bf16 v[96:99], v[24:27], v[228:231], v[96:99]
    ds_write_b128 v220, v[92:95] offset:33792
    v_mfma_f32_16x16x32_bf16 v[100:103], v[28:31], v[228:231], v[100:103]
    ds_write_b128 v220, v[112:115] offset:38912
    v_mfma_f32_16x16x32_bf16 v[120:123], v[24:27], v[232:235], v[120:123]
    ds_write_b128 v220, v[116:119] offset:39936
    v_mfma_f32_16x16x32_bf16 v[124:127], v[28:31], v[232:235], v[124:127]
    ds_write_b128 v220, v[96:99] offset:34816
    s_nop 0
    ds_write_b128 v220, v[100:103] offset:35840
    s_nop 1
    ds_write_b128 v12, v[120:123]
    s_nop 1
    ds_write_b128 v12, v[124:127] offset:1024
    s_mov_b64 exec, 1
    ds_write_b32 v13, v251
    s_mov_b64 exec, -1
    s_branch L_PJ
L_LCK_6:
    s_waitcnt vmcnt(0)
    v_perm_b32 v163, v156, v152, s48
    v_perm_b32 v167, v156, v152, s49
    v_perm_b32 v171, v157, v153, s48
    s_waitcnt lgkmcnt(0)
    v_mfma_f32_16x16x32_bf16 v[80:83], v[24:27], v[160:163], v[80:83]
    v_perm_b32 v227, v157, v153, s49
    v_perm_b32 v231, v158, v154, s48
    v_mfma_f32_16x16x32_bf16 v[84:87], v[28:31], v[160:163], v[84:87]
    v_perm_b32 v235, v158, v154, s49
    v_mfma_f32_16x16x32_bf16 v[104:107], v[24:27], v[164:167], v[104:107]
    v_mfma_f32_16x16x32_bf16 v[108:111], v[28:31], v[164:167], v[108:111]
    ds_write_b128 v220, v[80:83] offset:6144
    v_mfma_f32_16x16x32_bf16 v[88:91], v[24:27], v[168:171], v[88:91]
    ds_write_b128 v220, v[84:87] offset:7168
    v_mfma_f32_16x16x32_bf16 v[92:95], v[28:31], v[168:171], v[92:95]
    ds_write_b128 v220, v[104:107] offset:36864
    v_mfma_f32_16x16x32_bf16 v[112:115], v[24:27], v[224:227], v[112:115]
    ds_write_b128 v220, v[108:111] offset:37888
    v_mfma_f32_16x16x32_bf16 v[116:119], v[28:31], v[224:227], v[116:119]
    ds_write_b128 v220, v[88:91] offset:32768
    v_mfma_f32_16x16x32_bf16 v[96:99], v[24:27], v[228:231], v[96:99]
    ds_write_b128 v220, v[92:95] offset:33792
    v_mfma_f32_16x16x32_bf16 v[100:103], v[28:31], v[228:231], v[100:103]
    ds_write_b128 v220, v[112:115] offset:38912
    v_mfma_f32_16x16x32_bf16 v[120:123], v[24:27], v[232:235], v[120:123]
    ds_write_b128 v220, v[116:119] offset:39936
    v_mfma_f32_16x16x32_bf16 v[124:127], v[28:31], v[232:235], v[124:127]
    ds_write_b128 v220, v[96:99] offset:34816
    v_mfma_f32_16x16x32_bf16 v[56:59], v[16:19], v[164:167], v[56:59]
    ds_write_b128 v220, v[100:103] offset:35840
    v_mfma_f32_16x16x32_bf16 v[60:63], v[20:23], v[164:167], v[60:63]
    ds_write_b128 v12, v[120:123]
    v_mfma_f32_16x16x32_bf16 v[64:67], v[16:19], v[224:227], v[64:67]
    ds_write_b128 v12, v[124:127] offset:1024
    s_mov_b64 exec, 1
    ds_write_b32 v13, v255
    s_mov_b64 exec, -1
    v_mfma_f32_16x16x32_bf16 v[68:71], v[20:23], v[224:227], v[68:71]
    ds_write_b128 v220, v[56:59]
    v_mfma_f32_16x16x32_bf16 v[72:75], v[16:19], v[232:235], v[72:75]
    ds_write_b128 v220, v[60:63] offset:1024
    v_mfma_f32_16x16x32_bf16 v[76:79], v[20:23], v[232:235], v[76:79]
    ds_write_b128 v220, v[64:67] offset:2048
    v_mfma_f32_16x16x32_bf16 v[32:35], v[16:19], v[160:163], v[32:35]
    ds_write_b128 v220, v[68:71] offset:3072
    v_mfma_f32_16x16x32_bf16 v[36:39], v[20:23], v[160:163], v[36:39]
    ds_write_b128 v220, v[72:75] offset:4096
    v_mfma_f32_16x16x32_bf16 v[40:43], v[16:19], v[168:171], v[40:43]
    ds_write_b128 v220, v[76:79] offset:5120
    s_mov_b64 exec, 1
    ds_write_b32 v13, v251
    s_mov_b64 exec, -1
    v_mfma_f32_16x16x32_bf16 v[44:47], v[20:23], v[168:171], v[44:47]
    v_mfma_f32_16x16x32_bf16 v[48:51], v[16:19], v[228:231], v[48:51]
    v_mfma_f32_16x16x32_bf16 v[52:55], v[20:23], v[228:231], v[52:55]
    s_nop 7
L_PJ:
    s_cmp_eq_u32 s77, 0
    s_cbranch_scc1 L_NQE
    buffer_load_dwordx4 v[172:175], v236, s[20:23], s56 offen nt
    buffer_load_dwordx4 v[176:179], v236, s[20:23], s57 offen nt
    buffer_load_dwordx4 v[180:183], v236, s[20:23], s58 offen nt
    buffer_load_dwordx4 v[184:187], v236, s[20:23], s59 offen nt
    buffer_load_dwordx4 v[188:191], v236, s[20:23], s56 offen offset:128 nt
    buffer_load_dwordx4 v[192:195], v236, s[20:23], s57 offen offset:128 nt
    buffer_load_dwordx4 v[196:199], v236, s[20:23], s58 offen offset:128 nt
    buffer_load_dwordx4 v[200:203], v236, s[20:23], s59 offen offset:128 nt
L_NQE:
L_PF_7:
    ds_read_b32 v9, v10
    s_waitcnt lgkmcnt(0)
    v_cmp_gt_u32 vcc, s73, v9
    s_cbranch_vccnz L_PF_7
    ds_read_b128 v[56:59], v221
    ds_read_b128 v[80:83], v222 offset:6144
    ds_read_b128 v[104:107], v223 offset:36864
    ds_read_b128 v[60:63], v221 offset:1024
    ds_read_b128 v[84:87], v222 offset:7168
    ds_read_b128 v[108:111], v223 offset:37888
    ds_read_b128 v[64:67], v221 offset:2048
    ds_read_b128 v[88:91], v222 offset:32768
    ds_read_b128 v[112:115], v223 offset:38912
    ds_read_b128 v[68:71], v221 offset:3072
    ds_read_b128 v[92:95], v222 offset:33792
    ds_read_b128 v[116:119], v223 offset:39936
    ds_read_b128 v[72:75], v221 offset:4096
    ds_read_b128 v[96:99], v222 offset:34816
    ds_read_b128 v[120:123], v14
    v_add_u32 v250, 0x9e3779b1, v248
    s_waitcnt lgkmcnt(12)
    ds_read_b128 v[76:79], v221 offset:5120
    ds_read_b128 v[100:103], v222 offset:35840
    ds_read_b128 v[124:127], v14 offset:1024
    v_pk_add_f32 v[32:33], v[32:33], v[56:57]
    v_pk_add_f32 v[80:81], v[80:81], v[104:105]
    v_pk_add_f32 v[34:35], v[34:35], v[58:59]
    v_pk_add_f32 v[82:83], v[82:83], v[106:107]
    v_pk_add_f32 v[32:33], v[32:33], v[80:81]
    v_pk_add_f32 v[34:35], v[34:35], v[82:83]
    v_max3_f32 v6, v6, |v32|, |v33|
    v_max3_f32 v6, v6, |v34|, |v35|
    s_waitcnt lgkmcnt(12)
    v_pk_add_f32 v[36:37], v[36:37], v[60:61]
    v_pk_add_f32 v[84:85], v[84:85], v[108:109]
    v_pk_add_f32 v[38:39], v[38:39], v[62:63]
    v_pk_add_f32 v[86:87], v[86:87], v[110:111]
    v_pk_add_f32 v[36:37], v[36:37], v[84:85]
    v_pk_add_f32 v[38:39], v[38:39], v[86:87]
    v_max3_f32 v6, v6, |v36|, |v37|
    v_max3_f32 v6, v6, |v38|, |v39|
    s_waitcnt lgkmcnt(9)
    v_pk_add_f32 v[40:41], v[40:41], v[64:65]
    v_pk_add_f32 v[88:89], v[88:89], v[112:113]
    v_pk_add_f32 v[42:43], v[42:43], v[66:67]
    v_pk_add_f32 v[90:91], v[90:91], v[114:115]
    v_pk_add_f32 v[40:41], v[40:41], v[88:89]
    v_pk_add_f32 v[42:43], v[42:43], v[90:91]
    v_max3_f32 v6, v6, |v40|, |v41|
    v_max3_f32 v6, v6, |v42|, |v43|
    s_waitcnt lgkmcnt(6)
    v_pk_add_f32 v[44:45], v[44:45], v[68:69]
    v_pk_add_f32 v[92:93], v[92:93], v[116:117]
    v_pk_add_f32 v[46:47], v[46:47], v[70:71]
    v_pk_add_f32 v[94:95], v[94:95], v[118:119]
    v_pk_add_f32 v[44:45], v[44:45], v[92:93]
    v_pk_add_f32 v[46:47], v[46:47], v[94:95]
    v_max3_f32 v6, v6, |v44|, |v45|
    v_max3_f32 v6, v6, |v46|, |v47|
    s_waitcnt lgkmcnt(3)
    v_pk_add_f32 v[48:49], v[48:49], v[72:73]
    v_pk_add_f32 v[96:97], v[96:97], v[120:121]
    v_pk_add_f32 v[50:51], v[50:51], v[74:75]
    v_pk_add_f32 v[98:99], v[98:99], v[122:123]
    v_pk_add_f32 v[48:49], v[48:49], v[96:97]
    v_pk_add_f32 v[50:51], v[50:51], v[98:99]
    v_max3_f32 v6, v6, |v48|, |v49|
    v_max3_f32 v6, v6, |v50|, |v51|
    s_waitcnt lgkmcnt(0)
    v_pk_add_f32 v[52:53], v[52:53], v[76:77]
    v_pk_add_f32 v[100:101], v[100:101], v[124:125]
    v_pk_add_f32 v[54:55], v[54:55], v[78:79]
    v_pk_add_f32 v[102:103], v[102:103], v[126:127]
    v_pk_add_f32 v[52:53], v[52:53], v[100:101]
    v_pk_add_f32 v[54:55], v[54:55], v[102:103]
    v_max3_f32 v6, v6, |v52|, |v53|
    v_max3_f32 v6, v6, |v54|, |v55|
    s_cmp_eq_u32 s69, 0
    s_nop 0
    s_cbranch_scc1 L_KEEP
    v_and_b32 v6, s70, v6
    v_subrev_u32 v7, 0x7000000, v6
    v_sub_u32 v6, 0x86000000, v6
    s_cmp_eq_u32 s46, 2
    s_nop 0
    s_cbranch_scc0 L_MS_8
    v_pk_mul_f32 v[32:33], v[32:33], v[6:7] op_sel_hi:[1,0]
    v_pk_mul_f32 v[34:35], v[34:35], v[6:7] op_sel_hi:[1,0]
    v_pk_mul_f32 v[36:37], v[36:37], v[6:7] op_sel_hi:[1,0]
    v_pk_mul_f32 v[38:39], v[38:39], v[6:7] op_sel_hi:[1,0]
    v_cvt_pk_f16_f32 v152, v32, v33
    v_cvt_pk_f16_f32 v153, v34, v35
    v_add_u32 v152, v152, v248
    v_cvt_pk_f16_f32 v154, v36, v37
    v_cvt_pk_f16_f32 v155, v38, v39
    buffer_store_dwordx4 v[152:155], v244, s[36:39], s71 offen
    v_add3_u32 v164, v248, v152, v153
    v_add3_u32 v164, v164, v154, v155
    v_pk_mul_f32 v[40:41], v[40:41], v[6:7] op_sel_hi:[1,0]
    v_pk_mul_f32 v[42:43], v[42:43], v[6:7] op_sel_hi:[1,0]
    v_pk_mul_f32 v[44:45], v[44:45], v[6:7] op_sel_hi:[1,0]
    v_pk_mul_f32 v[46:47], v[46:47], v[6:7] op_sel_hi:[1,0]
    v_cvt_pk_f16_f32 v156, v40, v41
    v_cvt_pk_f16_f32 v157, v42, v43
    v_add_u32 v156, v156, v248
    v_cvt_pk_f16_f32 v158, v44, v45
    v_cvt_pk_f16_f32 v159, v46, v47
    buffer_store_dwordx4 v[156:159], v244, s[36:39], s71 offen offset:1024
    v_add3_u32 v164, v164, v156, v157
    v_add3_u32 v164, v164, v158, v159
    v_pk_mul_f32 v[48:49], v[48:49], v[6:7] op_sel_hi:[1,0]
    v_pk_mul_f32 v[50:51], v[50:51], v[6:7] op_sel_hi:[1,0]
    v_pk_mul_f32 v[52:53], v[52:53], v[6:7] op_sel_hi:[1,0]
    v_pk_mul_f32 v[54:55], v[54:55], v[6:7] op_sel_hi:[1,0]
    v_cvt_pk_f16_f32 v160, v48, v49
    v_cvt_pk_f16_f32 v161, v50, v51
    v_add_u32 v160, v160, v248
    v_cvt_pk_f16_f32 v162, v52, v53
    v_cvt_pk_f16_f32 v163, v54, v55
    buffer_store_dwordx4 v[160:163], v244, s[36:39], s71 offen offset:2048
    v_add3_u32 v164, v164, v160, v161
    v_add3_u32 v164, v164, v162, v163
    v_bfi_b32 v164, s70, v7, v164
    buffer_store_dword v164, v249, s[36:39], s71 offen offset:3072
    s_nop 0
    s_branch L_MJ_9
L_MS_8:
    v_pk_mul_f32 v[32:33], v[32:33], v[6:7] op_sel_hi:[1,0]
    v_pk_mul_f32 v[34:35], v[34:35], v[6:7] op_sel_hi:[1,0]
    v_pk_mul_f32 v[36:37], v[36:37], v[6:7] op_sel_hi:[1,0]
    v_pk_mul_f32 v[38:39], v[38:39], v[6:7] op_sel_hi:[1,0]
    v_cvt_pk_f16_f32 v152, v32, v33
    v_cvt_pk_f16_f32 v153, v34, v35
    v_add_u32 v152, v152, v248
    v_cvt_pk_f16_f32 v154, v36, v37
    v_cvt_pk_f16_f32 v155, v38, v39
    buffer_store_dwordx4 v[152:155], v244, s[36:39], s71 offen sc1
    v_add3_u32 v164, v248, v152, v153
    v_add3_u32 v164, v164, v154, v155
    v_pk_mul_f32 v[40:41], v[40:41], v[6:7] op_sel_hi:[1,0]
    v_pk_mul_f32 v[42:43], v[42:43], v[6:7] op_sel_hi:[1,0]
    v_pk_mul_f32 v[44:45], v[44:45], v[6:7] op_sel_hi:[1,0]
    v_pk_mul_f32 v[46:47], v[46:47], v[6:7] op_sel_hi:[1,0]
    v_cvt_pk_f16_f32 v156, v40, v41
    v_cvt_pk_f16_f32 v157, v42, v43
    v_add_u32 v156, v156, v248
    v_cvt_pk_f16_f32 v158, v44, v45
    v_cvt_pk_f16_f32 v159, v46, v47
    buffer_store_dwordx4 v[156:159], v244, s[36:39], s71 offen offset:1024 sc1
    v_add3_u32 v164, v164, v156, v157
    v_add3_u32 v164, v164, v158, v159
    v_pk_mul_f32 v[48:49], v[48:49], v[6:7] op_sel_hi:[1,0]
    v_pk_mul_f32 v[50:51], v[50:51], v[6:7] op_sel_hi:[1,0]
    v_pk_mul_f32 v[52:53], v[52:53], v[6:7] op_sel_hi:[1,0]
    v_pk_mul_f32 v[54:55], v[54:55], v[6:7] op_sel_hi:[1,0]
    v_cvt_pk_f16_f32 v160, v48, v49
    v_cvt_pk_f16_f32 v161, v50, v51
    v_add_u32 v160, v160, v248
    v_cvt_pk_f16_f32 v162, v52, v53
    v_cvt_pk_f16_f32 v163, v54, v55
    buffer_store_dwordx4 v[160:163], v244, s[36:39], s71 offen offset:2048 sc1
    v_add3_u32 v164, v164, v160, v161
    v_add3_u32 v164, v164, v162, v163
    v_bfi_b32 v164, s70, v7, v164
    buffer_store_dword v164, v249, s[36:39], s71 offen offset:3072 sc1
    s_nop 0
L_MJ_9:
    s_branch L_PQ
L_KEEP:
    s_mov_b32 s54, 0x186a0
L_PC_10:
    buffer_load_dword v164, v249, s[36:39], s71 offen offset:3072 sc1
    buffer_load_dwordx4 v[152:155], v244, s[36:39], s71 offen sc1
    buffer_load_dwordx4 v[156:159], v244, s[36:39], s71 offen offset:1024 sc1
    buffer_load_dwordx4 v[160:163], v244, s[36:39], s71 offen offset:2048 sc1
    s_waitcnt vmcnt(2)
    v_and_b32 v6, s70, v164
    v_add3_u32 v8, v248, v152, v153
    v_add3_u32 v8, v8, v154, v155
    v_sub_u32 v152, v152, v248
    v_fma_mix_f32 v134, v155, v6, v38 op_sel_hi:[1,0,0]
    v_fma_mix_f32 v135, v155, v6, v39 op_sel:[1,0,0] op_sel_hi:[1,0,0]
    v_fma_mix_f32 v132, v154, v6, v36 op_sel_hi:[1,0,0]
    v_fma_mix_f32 v133, v154, v6, v37 op_sel:[1,0,0] op_sel_hi:[1,0,0]
    v_fma_mix_f32 v130, v153, v6, v34 op_sel_hi:[1,0,0]
    v_fma_mix_f32 v131, v153, v6, v35 op_sel:[1,0,0] op_sel_hi:[1,0,0]
    v_fma_mix_f32 v128, v152, v6, v32 op_sel_hi:[1,0,0]
    v_fma_mix_f32 v129, v152, v6, v33 op_sel:[1,0,0] op_sel_hi:[1,0,0]
    s_waitcnt vmcnt(1)
    v_add3_u32 v8, v8, v156, v157
    v_add3_u32 v8, v8, v158, v159
    v_sub_u32 v156, v156, v248
    v_fma_mix_f32 v142, v159, v6, v46 op_sel_hi:[1,0,0]
    v_fma_mix_f32 v143, v159, v6, v47 op_sel:[1,0,0] op_sel_hi:[1,0,0]
    v_fma_mix_f32 v140, v158, v6, v44 op_sel_hi:[1,0,0]
    v_fma_mix_f32 v141, v158, v6, v45 op_sel:[1,0,0] op_sel_hi:[1,0,0]
    v_fma_mix_f32 v138, v157, v6, v42 op_sel_hi:[1,0,0]
    v_fma_mix_f32 v139, v157, v6, v43 op_sel:[1,0,0] op_sel_hi:[1,0,0]
    v_fma_mix_f32 v136, v156, v6, v40 op_sel_hi:[1,0,0]
    v_fma_mix_f32 v137, v156, v6, v41 op_sel:[1,0,0] op_sel_hi:[1,0,0]
    s_waitcnt vmcnt(0)
    v_add3_u32 v8, v8, v160, v161
    v_add3_u32 v8, v8, v162, v163
    v_sub_u32 v160, v160, v248
    v_bfi_b32 v8, s70, v6, v8
    v_cmp_ne_u32 vcc, v8, v164
    v_fma_mix_f32 v150, v163, v6, v54 op_sel_hi:[1,0,0]
    v_fma_mix_f32 v151, v163, v6, v55 op_sel:[1,0,0] op_sel_hi:[1,0,0]
    v_fma_mix_f32 v148, v162, v6, v52 op_sel_hi:[1,0,0]
    v_fma_mix_f32 v149, v162, v6, v53 op_sel:[1,0,0] op_sel_hi:[1,0,0]
    v_fma_mix_f32 v146, v161, v6, v50 op_sel_hi:[1,0,0]
    v_fma_mix_f32 v147, v161, v6, v51 op_sel:[1,0,0] op_sel_hi:[1,0,0]
    v_fma_mix_f32 v144, v160, v6, v48 op_sel_hi:[1,0,0]
    v_fma_mix_f32 v145, v160, v6, v49 op_sel:[1,0,0] op_sel_hi:[1,0,0]
    s_nop 1
    s_cbranch_vccz L_PCX_12
    s_sub_u32 s54, s54, 1
    s_cmp_lg_u32 s54, 0
    s_cbranch_scc1 L_PC_10
L_PCX_12:
    s_cmp_ge_u32 s47, 4
    s_cbranch_scc1 L_FV
    s_cmp_eq_u32 s46, 2
    s_cbranch_scc0 L_MS_13
    v_cvt_pk_bf16_f32 v16, v128, v132
    v_cvt_pk_bf16_f32 v17, v136, v140
    v_add_u32 v16, v16, v250
    v_cvt_pk_bf16_f32 v18, v144, v148
    v_cvt_pk_bf16_f32 v19, v129, v133
    buffer_store_dwordx4 v[16:19], v244, s[36:39], s60 offen
    v_add3_u32 v28, v250, v16, v17
    v_add3_u32 v28, v28, v18, v19
    v_cvt_pk_bf16_f32 v20, v137, v141
    v_cvt_pk_bf16_f32 v21, v145, v149
    v_add_u32 v20, v20, v250
    v_cvt_pk_bf16_f32 v22, v130, v134
    v_cvt_pk_bf16_f32 v23, v138, v142
    buffer_store_dwordx4 v[20:23], v244, s[36:39], s60 offen offset:1024
    v_add3_u32 v28, v28, v20, v21
    v_add3_u32 v28, v28, v22, v23
    v_cvt_pk_bf16_f32 v24, v146, v150
    v_cvt_pk_bf16_f32 v25, v131, v135
    v_add_u32 v24, v24, v250
    v_cvt_pk_bf16_f32 v26, v139, v143
    v_cvt_pk_bf16_f32 v27, v147, v151
    buffer_store_dwordx4 v[24:27], v244, s[36:39], s60 offen offset:2048
    v_add3_u32 v28, v28, v24, v25
    v_add3_u32 v28, v28, v26, v27
    buffer_store_dword v28, v249, s[36:39], s60 offen offset:3072
    s_nop 0
    s_branch L_MJ_14
L_MS_13:
    v_cvt_pk_bf16_f32 v16, v128, v132
    v_cvt_pk_bf16_f32 v17, v136, v140
    v_add_u32 v16, v16, v250
    v_cvt_pk_bf16_f32 v18, v144, v148
    v_cvt_pk_bf16_f32 v19, v129, v133
    buffer_store_dwordx4 v[16:19], v244, s[36:39], s60 offen sc1
    v_add3_u32 v28, v250, v16, v17
    v_add3_u32 v28, v28, v18, v19
    v_cvt_pk_bf16_f32 v20, v137, v141
    v_cvt_pk_bf16_f32 v21, v145, v149
    v_add_u32 v20, v20, v250
    v_cvt_pk_bf16_f32 v22, v130, v134
    v_cvt_pk_bf16_f32 v23, v138, v142
    buffer_store_dwordx4 v[20:23], v244, s[36:39], s60 offen offset:1024 sc1
    v_add3_u32 v28, v28, v20, v21
    v_add3_u32 v28, v28, v22, v23
    v_cvt_pk_bf16_f32 v24, v146, v150
    v_cvt_pk_bf16_f32 v25, v131, v135
    v_add_u32 v24, v24, v250
    v_cvt_pk_bf16_f32 v26, v139, v143
    v_cvt_pk_bf16_f32 v27, v147, v151
    buffer_store_dwordx4 v[24:27], v244, s[36:39], s60 offen offset:2048 sc1
    v_add3_u32 v28, v28, v24, v25
    v_add3_u32 v28, v28, v26, v27
    buffer_store_dword v28, v249, s[36:39], s60 offen offset:3072 sc1
    s_nop 0
L_MJ_14:
    v_sub_u32 v16, v16, v250
    v_sub_u32 v20, v20, v250
    v_sub_u32 v24, v24, v250
    ds_write_b128 v246, v[16:19]
    ds_write_b128 v246, v[20:23] offset:512
    ds_write_b128 v246, v[24:27] offset:1024
    s_mov_b64 exec, 1
    ds_add_u32 v251, v255 offset:20
    ds_add_u32 v251, v255 offset:28
    s_mov_b64 exec, -1
    s_branch L_PQ
L_FV:
    s_cmp_eq_u32 s46, 2
    s_cbranch_scc0 L_MS_15
    v_cvt_pk_bf16_f32 v16, v128, v129
    v_cvt_pk_bf16_f32 v17, v130, v131
    v_add_u32 v16, v16, v250
    v_cvt_pk_bf16_f32 v18, v132, v133
    v_cvt_pk_bf16_f32 v19, v134, v135
    buffer_store_dwordx4 v[16:19], v244, s[36:39], s60 offen
    v_add3_u32 v28, v250, v16, v17
    v_add3_u32 v28, v28, v18, v19
    v_cvt_pk_bf16_f32 v20, v136, v137
    v_cvt_pk_bf16_f32 v21, v138, v139
    v_add_u32 v20, v20, v250
    v_cvt_pk_bf16_f32 v22, v140, v141
    v_cvt_pk_bf16_f32 v23, v142, v143
    buffer_store_dwordx4 v[20:23], v244, s[36:39], s60 offen offset:1024
    v_add3_u32 v28, v28, v20, v21
    v_add3_u32 v28, v28, v22, v23
    v_cvt_pk_bf16_f32 v24, v144, v145
    v_cvt_pk_bf16_f32 v25, v146, v147
    v_add_u32 v24, v24, v250
    v_cvt_pk_bf16_f32 v26, v148, v149
    v_cvt_pk_bf16_f32 v27, v150, v151
    buffer_store_dwordx4 v[24:27], v244, s[36:39], s60 offen offset:2048
    v_add3_u32 v28, v28, v24, v25
    v_add3_u32 v28, v28, v26, v27
    buffer_store_dword v28, v249, s[36:39], s60 offen offset:3072
    s_nop 0
    s_branch L_MJ_16
L_MS_15:
    v_cvt_pk_bf16_f32 v16, v128, v129
    v_cvt_pk_bf16_f32 v17, v130, v131
    v_add_u32 v16, v16, v250
    v_cvt_pk_bf16_f32 v18, v132, v133
    v_cvt_pk_bf16_f32 v19, v134, v135
    buffer_store_dwordx4 v[16:19], v244, s[36:39], s60 offen sc1
    v_add3_u32 v28, v250, v16, v17
    v_add3_u32 v28, v28, v18, v19
    v_cvt_pk_bf16_f32 v20, v136, v137
    v_cvt_pk_bf16_f32 v21, v138, v139
    v_add_u32 v20, v20, v250
    v_cvt_pk_bf16_f32 v22, v140, v141
    v_cvt_pk_bf16_f32 v23, v142, v143
    buffer_store_dwordx4 v[20:23], v244, s[36:39], s60 offen offset:1024 sc1
    v_add3_u32 v28, v28, v20, v21
    v_add3_u32 v28, v28, v22, v23
    v_cvt_pk_bf16_f32 v24, v144, v145
    v_cvt_pk_bf16_f32 v25, v146, v147
    v_add_u32 v24, v24, v250
    v_cvt_pk_bf16_f32 v26, v148, v149
    v_cvt_pk_bf16_f32 v27, v150, v151
    buffer_store_dwordx4 v[24:27], v244, s[36:39], s60 offen offset:2048 sc1
    v_add3_u32 v28, v28, v24, v25
    v_add3_u32 v28, v28, v26, v27
    buffer_store_dword v28, v249, s[36:39], s60 offen offset:3072 sc1
    s_nop 0
L_MJ_16:
    v_sub_u32 v16, v16, v250
    v_sub_u32 v20, v20, v250
    v_sub_u32 v24, v24, v250
    ds_write_b128 v247, v[16:19]
    ds_write_b128 v247, v[20:23] offset:8192
    ds_write_b128 v247, v[24:27] offset:16384
    s_mov_b64 exec, 1
    ds_add_u32 v251, v255 offset:24
    ds_add_u32 v251, v255 offset:28
    s_mov_b64 exec, -1
L_PQ:
    s_and_b32 s52, s44, 1
    s_lshl_b32 s53, s69, 1
    s_add_u32 s52, s52, s53
    s_and_b32 s55, s45, 3
    s_bitcmp1_b32 10, s55
    s_mov_b32 s53, 0x10101010
    s_cselect_b32 s53, 0x8080808, s53
    s_lshl_b32 s73, s52, 3
    s_lshr_b32 s73, s53, s73
    s_and_b32 s73, s73, 255
    ds_read_b32 v9, v251 offset:32
    s_branch L_LPC_18
L_LP_17:
    s_sleep 2
    ds_read_b32 v9, v251 offset:32
L_LPC_18:
    s_waitcnt lgkmcnt(0)
    v_cmp_gt_u32 vcc, s73, v9
    s_cbranch_vccnz L_LP_17
    s_cmp_eq_u32 s77, 0
    s_cbranch_scc0 L_QL
    buffer_load_dwordx4 v[172:175], v236, s[20:23], s56 offen nt
    buffer_load_dwordx4 v[176:179], v236, s[20:23], s57 offen nt
    buffer_load_dwordx4 v[180:183], v236, s[20:23], s58 offen nt
    buffer_load_dwordx4 v[184:187], v236, s[20:23], s59 offen nt
    buffer_load_dwordx4 v[188:191], v236, s[20:23], s56 offen offset:128 nt
    buffer_load_dwordx4 v[192:195], v236, s[20:23], s57 offen offset:128 nt
    buffer_load_dwordx4 v[196:199], v236, s[20:23], s58 offen offset:128 nt
    buffer_load_dwordx4 v[200:203], v236, s[20:23], s59 offen offset:128 nt
L_QL:
    buffer_load_dwordx4 v[204:207], v236, s[20:23], s56 offen offset:256 nt
    buffer_load_dwordx4 v[208:211], v236, s[20:23], s57 offen offset:256 nt
    buffer_load_dwordx4 v[212:215], v236, s[20:23], s58 offen offset:256 nt
    buffer_load_dwordx4 v[216:219], v236, s[20:23], s59 offen offset:256 nt
    s_mov_b32 s76, 0
    s_branch L_S
L_HELP:
    s_setprio 3
    s_mov_b32 s36, s18
    s_mov_b32 s37, s19
    s_mov_b32 s38, 0x1a0000
    s_mov_b32 s39, 0x00020000
    v_lshlrev_b32 v244, 4, v1
    v_mov_b32 v12, -1
    v_mov_b32 v13, -1
    v_mov_b32 v14, -1
    v_mov_b32 v15, -1
    s_lshl_b32 s65, s45, 3
    s_add_u32 s64, s65, s47
    v_mov_b32 v17, 0
    s_mul_i32 s52, s45, 53248
    s_cmp_eq_u32 s44, 7
    s_cbranch_scc0 L_NTL
    buffer_load_dwordx4 v[24:27], v17, s[36:39], s52 offen sc1
    buffer_load_dwordx4 v[28:31], v17, s[36:39], s52 offen offset:1024 sc1
    buffer_load_dwordx4 v[32:35], v17, s[36:39], s52 offen offset:2048 sc1
    buffer_load_dword v18, v17, s[36:39], s52 offen offset:3072 sc1
L_NTL:
    s_mov_b32 s40, s16
    s_mov_b32 s41, s17
    s_mov_b32 s42, 0x100
    s_mov_b32 s43, 0x00020000
    s_getreg_b32 s53, hwreg(HW_REG_XCC_ID)
    s_and_b32 s53, s53, 15
    s_add_u32 s53, s53, 1
    v_mov_b32 v16, s53
    v_mov_b32 v17, 0
    s_nop 1
L_H0:
    s_mov_b32 s20, s4
    s_mov_b32 s21, s5
    s_mov_b32 s22, 0x1800000
    s_mov_b32 s23, 0x00020000
    s_mov_b32 s32, s14
    s_mov_b32 s33, s15
    s_mov_b32 s34, 0x1800000
    s_mov_b32 s35, 0x00020000
    s_mov_b32 s36, s18
    s_mov_b32 s37, s19
    s_mov_b32 s38, 0x1a0000
    s_mov_b32 s39, 0x00020000
    v_lshrrev_b32 v224, 3, v1
    v_and_b32 v225, 7, v1
    v_mul_u32_u24 v236, 384, v224
    v_lshl_add_u32 v236, v225, 4, v236
    s_lshl_b32 s52, s44, 12
    s_add_u32 s52, s52, 98304
    v_lshrrev_b32 v226, 4, v1
    v_xor_b32 v226, v226, v225
    v_lshlrev_b32 v226, 4, v226
    v_lshl_add_u32 v226, v224, 7, v226
    v_add_u32 v237, s52, v226
    v_xor_b32 v238, 64, v237
    v_and_b32 v224, 31, v1
    v_lshrrev_b32 v225, 5, v1
    v_bfe_u32 v226, v1, 1, 3
    v_xor_b32 v226, v226, v225
    v_lshlrev_b32 v226, 4, v226
    v_lshl_add_u32 v226, v224, 7, v226
    v_add_u32 v239, s52, v226
    v_xor_b32 v240, 32, v239
    v_xor_b32 v241, 64, v239
    v_xor_b32 v242, 96, v239
    v_mul_u32_u24 v243, 12, v224
    v_mul_u32_u24 v226, 1536, v225
    v_add_u32 v243, v243, v226
    v_lshlrev_b32 v244, 4, v1
    v_add_u32 v245, 0x10000, v244
    v_lshlrev_b32 v249, 2, v1
    s_lshl_b32 s52, s47, 3
    s_add_u32 s52, s52, s44
    s_mul_i32 s52, s52, 12288
    s_mul_i32 s56, s45, 786432
    s_add_u32 s56, s56, s52
    s_add_u32 s57, s56, 3072
    s_add_u32 s58, s56, 6144
    s_add_u32 s59, s56, 9216
    s_lshr_b32 s52, s44, 1
    s_xor_b32 s52, s52, s47
    s_and_b32 s69, s52, 1
    v_and_b32 v224, 15, v1
    v_lshrrev_b32 v225, 4, v1
    s_bfe_u32 s52, s44, 0x10001
    s_and_b32 s53, s44, 1
    s_mul_i32 s54, s52, 12288
    s_lshl_b32 s55, s53, 8
    s_add_u32 s54, s54, s55
    s_add_u32 s54, s54, 65536
    v_mul_u32_u24 v226, 1536, v225
    v_lshl_add_u32 v226, v224, 4, v226
    v_add_u32 v246, s54, v226
    s_lshl_b32 s54, s52, 11
    s_lshl_b32 s55, s53, 12
    s_add_u32 s54, s54, s55
    s_add_u32 s54, s54, 90112
    v_lshlrev_b32 v226, 9, v225
    v_lshl_add_u32 v226, v224, 4, v226
    v_add_u32 v247, s54, v226
    s_mul_i32 s60, s45, 53248
    s_mul_i32 s54, s52, 6656
    s_add_u32 s60, s60, s54
    s_mul_i32 s55, s53, 3328
    s_add_u32 s60, s60, s55
    s_cmp_eq_u32 s44, 7
    s_cbranch_scc0 L_H1
    s_waitcnt vmcnt(0)
    s_mov_b64 exec, 1
    buffer_store_byte v16, v17, s[40:43], s64 offen sc1
    s_mov_b64 exec, -1
    v_add_u32 v24, v24, v25
    v_add3_u32 v24, v24, v26, v27
    v_add3_u32 v24, v24, v28, v29
    v_add3_u32 v24, v24, v30, v31
    v_add3_u32 v24, v24, v32, v33
    v_add3_u32 v24, v24, v34, v35
    v_sub_u32 v18, v18, v24
    v_add_u32 v18, 0x9e3779b1, v18
    s_mov_b64 exec, 1
    ds_write_b32 v251, v18 offset:72
    s_mov_b64 exec, -1
    ds_read_b32 v9, v251 offset:36
    s_branch L_LPC_20
L_LP_19:
    s_sleep 8
    ds_read_b32 v9, v251 offset:36
L_LPC_20:
    s_waitcnt lgkmcnt(0)
    v_cmp_gt_u32 vcc, 2, v9
    s_cbranch_vccnz L_LP_19
    s_mov_b32 s54, 0x186a0
    s_mov_b64 exec, 0xff
L_FL_21:
    buffer_load_ubyte v4, v1, s[40:43], s65 offen sc1
    s_waitcnt vmcnt(0)
    v_cmp_gt_u32 vcc, 1, v4
    s_cbranch_vccz L_FLX_22
    s_sleep 40
    s_sub_u32 s54, s54, 1
    s_cmp_lg_u32 s54, 0
    s_cbranch_scc1 L_FL_21
L_FLX_22:
    v_and_b32 v4, 63, v4
    s_nop 0
    v_readfirstlane_b32 s55, v4
    s_nop 1
    v_cmp_ne_u32 vcc, s55, v4
    s_nop 0
    s_cmp_eq_u64 vcc, 0
    s_cselect_b32 s46, 2, 1
    v_mov_b32 v4, s46
    s_mov_b64 exec, 1
    ds_write_b32 v251, v4 offset:16
    s_mov_b64 exec, -1
L_H1:
    s_and_b32 s52, s44, 3
    ds_read_b32 v9, v251 offset:32
    s_branch L_LPC_24
L_LP_23:
    s_sleep 2
    ds_read_b32 v9, v251 offset:32
L_LPC_24:
    s_waitcnt lgkmcnt(0)
    v_cmp_gt_u32 vcc, 4, v9
    s_cbranch_vccnz L_LP_23
    s_and_b32 s53, s44, 3
    s_mul_i32 s53, s53, 1664
    s_mul_i32 s54, s64, 6656
    s_add_u32 s53, s54, s53
    v_lshlrev_b32 v77, 7, v1
    s_mov_b64 exec, 0x1fff
    buffer_load_dword v76, v77, s[36:39], s53 offen
    s_mov_b64 exec, -1
    s_and_b32 s55, s45, 3
    s_bitcmp1_b32 10, s55
    s_cbranch_scc1 L_HB
    buffer_load_dwordx4 v[172:175], v236, s[20:23], s56 offen nt
    buffer_load_dwordx4 v[176:179], v236, s[20:23], s57 offen nt
    buffer_load_dwordx4 v[180:183], v236, s[20:23], s58 offen nt
    buffer_load_dwordx4 v[184:187], v236, s[20:23], s59 offen nt
    s_waitcnt vmcnt(0)
    ds_write_b128 v237, v[172:175]
    ds_write_b128 v238, v[176:179] offset:1024
    ds_write_b128 v237, v[180:183] offset:2048
    ds_write_b128 v238, v[184:187] offset:3072
    s_waitcnt lgkmcnt(0)
    ds_read_b128 v[172:175], v239
    ds_read_b128 v[176:179], v240
    ds_read_b128 v[180:183], v241
    ds_read_b128 v[184:187], v242
    s_waitcnt lgkmcnt(0)
    ds_read_b32 v9, v251 offset:28
    s_branch L_LPC_26
L_LP_25:
    s_sleep 1
    ds_read_b32 v9, v251 offset:28
L_LPC_26:
    s_waitcnt lgkmcnt(0)
    v_cmp_gt_u32 vcc, 2, v9
    s_cbranch_vccnz L_LP_25
    s_lshr_b32 s52, s47, 1
    s_lshl_b32 s53, s69, 2
    s_add_u32 s52, s52, s53
    s_mov_b32 s70, 15
    s_bitset0_b32 s70, s52
    s_bitcmp1_b32 s70, 0
    s_cbranch_scc0 L_SWI_27
    s_add_u32 s52, s60, 0
    buffer_load_dwordx4 v[12:15], v244, s[36:39], s52 offen sc1
    buffer_load_dwordx4 v[16:19], v244, s[36:39], s52 offen offset:1024 sc1
    buffer_load_dwordx4 v[20:23], v244, s[36:39], s52 offen offset:2048 sc1
    buffer_load_dword v24, v249, s[36:39], s52 offen offset:3072 sc1
L_SWI_27:
    s_bitcmp1_b32 s70, 1
    s_cbranch_scc0 L_SWI_28
    s_add_u32 s52, s60, 13312
    buffer_load_dwordx4 v[28:31], v244, s[36:39], s52 offen sc1
    buffer_load_dwordx4 v[32:35], v244, s[36:39], s52 offen offset:1024 sc1
    buffer_load_dwordx4 v[36:39], v244, s[36:39], s52 offen offset:2048 sc1
    buffer_load_dword v40, v249, s[36:39], s52 offen offset:3072 sc1
L_SWI_28:
    s_bitcmp1_b32 s70, 2
    s_cbranch_scc0 L_SWI_29
    s_add_u32 s52, s60, 26624
    buffer_load_dwordx4 v[44:47], v244, s[36:39], s52 offen sc1
    buffer_load_dwordx4 v[48:51], v244, s[36:39], s52 offen offset:1024 sc1
    buffer_load_dwordx4 v[52:55], v244, s[36:39], s52 offen offset:2048 sc1
    buffer_load_dword v56, v249, s[36:39], s52 offen offset:3072 sc1
L_SWI_29:
    s_bitcmp1_b32 s70, 3
    s_cbranch_scc0 L_SWI_30
    s_add_u32 s52, s60, 39936
    buffer_load_dwordx4 v[60:63], v244, s[36:39], s52 offen sc1
    buffer_load_dwordx4 v[64:67], v244, s[36:39], s52 offen offset:1024 sc1
    buffer_load_dwordx4 v[68:71], v244, s[36:39], s52 offen offset:2048 sc1
    buffer_load_dword v72, v249, s[36:39], s52 offen offset:3072 sc1
L_SWI_30:
    ds_read_b32 v248, v251 offset:72
    s_mov_b64 exec, 1
    ds_add_u32 v251, v255 offset:32
    s_mov_b64 exec, -1
    s_and_b32 s52, s44, 3
L_LP_31:
    ds_read_b32 v9, v251 offset:32
    s_waitcnt lgkmcnt(0)
    v_cmp_gt_u32 vcc, 8, v9
    s_cbranch_vccnz L_LP_31
    buffer_load_dwordx4 v[188:191], v236, s[20:23], s56 offen offset:128 nt
    buffer_load_dwordx4 v[192:195], v236, s[20:23], s57 offen offset:128 nt
    buffer_load_dwordx4 v[196:199], v236, s[20:23], s58 offen offset:128 nt
    buffer_load_dwordx4 v[200:203], v236, s[20:23], s59 offen offset:128 nt
    buffer_load_dwordx4 v[204:207], v236, s[20:23], s56 offen offset:256 nt
    buffer_load_dwordx4 v[208:211], v236, s[20:23], s57 offen offset:256 nt
    buffer_load_dwordx4 v[212:215], v236, s[20:23], s58 offen offset:256 nt
    buffer_load_dwordx4 v[216:219], v236, s[20:23], s59 offen offset:256 nt
    s_mov_b64 exec, 1
    ds_add_u32 v251, v255 offset:32
    s_mov_b64 exec, -1
    s_waitcnt lgkmcnt(0)
    v_add_u32 v248, 0x9e3779b1, v248
    s_mov_b32 s54, 0x186a0
    s_waitcnt vmcnt(8)
    s_branch L_SW_33f
L_SW_33:
    s_waitcnt vmcnt(0)
L_SW_33f:
    s_sub_u32 s54, s54, 1
    s_bitcmp1_b32 s70, 0
    s_cbranch_scc0 L_SWN_34
    v_add3_u32 v8, v248, v12, v13
    v_add3_u32 v10, v14, v15, v16
    v_add3_u32 v8, v8, v17, v18
    v_add3_u32 v10, v10, v19, v20
    v_add3_u32 v8, v8, v21, v22
    v_add3_u32 v8, v8, v10, v23
    v_cmp_ne_u32 vcc, v8, v24
    v_sub_u32 v12, v12, v248
    v_sub_u32 v16, v16, v248
    v_sub_u32 v20, v20, v248
    s_nop 1
    s_cbranch_vccz L_SWW_35
    s_cmp_eq_u32 s54, 0
    s_cbranch_scc1 L_SWW_35
    s_add_u32 s52, s60, 0
    buffer_load_dwordx4 v[12:15], v244, s[36:39], s52 offen sc1
    buffer_load_dwordx4 v[16:19], v244, s[36:39], s52 offen offset:1024 sc1
    buffer_load_dwordx4 v[20:23], v244, s[36:39], s52 offen offset:2048 sc1
    buffer_load_dword v24, v249, s[36:39], s52 offen offset:3072 sc1
    s_branch L_SWN_34
L_SWW_35:
    ds_write_b128 v246, v[12:15]
    ds_write_b128 v246, v[16:19] offset:512
    ds_write_b128 v246, v[20:23] offset:1024
    s_mov_b64 exec, 1
    ds_add_u32 v251, v255 offset:20
    s_mov_b64 exec, -1
    s_bitset0_b32 s70, 0
L_SWN_34:
    s_bitcmp1_b32 s70, 1
    s_cbranch_scc0 L_SWN_36
    v_add3_u32 v8, v248, v28, v29
    v_add3_u32 v10, v30, v31, v32
    v_add3_u32 v8, v8, v33, v34
    v_add3_u32 v10, v10, v35, v36
    v_add3_u32 v8, v8, v37, v38
    v_add3_u32 v8, v8, v10, v39
    v_cmp_ne_u32 vcc, v8, v40
    v_sub_u32 v28, v28, v248
    v_sub_u32 v32, v32, v248
    v_sub_u32 v36, v36, v248
    s_nop 1
    s_cbranch_vccz L_SWW_37
    s_cmp_eq_u32 s54, 0
    s_cbranch_scc1 L_SWW_37
    s_add_u32 s52, s60, 13312
    buffer_load_dwordx4 v[28:31], v244, s[36:39], s52 offen sc1
    buffer_load_dwordx4 v[32:35], v244, s[36:39], s52 offen offset:1024 sc1
    buffer_load_dwordx4 v[36:39], v244, s[36:39], s52 offen offset:2048 sc1
    buffer_load_dword v40, v249, s[36:39], s52 offen offset:3072 sc1
    s_branch L_SWN_36
L_SWW_37:
    ds_write_b128 v246, v[28:31] offset:6144
    ds_write_b128 v246, v[32:35] offset:6656
    ds_write_b128 v246, v[36:39] offset:7168
    s_mov_b64 exec, 1
    ds_add_u32 v251, v255 offset:20
    s_mov_b64 exec, -1
    s_bitset0_b32 s70, 1
L_SWN_36:
    s_bitcmp1_b32 s70, 2
    s_cbranch_scc0 L_SWN_38
    v_add3_u32 v8, v248, v44, v45
    v_add3_u32 v10, v46, v47, v48
    v_add3_u32 v8, v8, v49, v50
    v_add3_u32 v10, v10, v51, v52
    v_add3_u32 v8, v8, v53, v54
    v_add3_u32 v8, v8, v10, v55
    v_cmp_ne_u32 vcc, v8, v56
    v_sub_u32 v44, v44, v248
    v_sub_u32 v48, v48, v248
    v_sub_u32 v52, v52, v248
    s_nop 1
    s_cbranch_vccz L_SWW_39
    s_cmp_eq_u32 s54, 0
    s_cbranch_scc1 L_SWW_39
    s_add_u32 s52, s60, 26624
    buffer_load_dwordx4 v[44:47], v244, s[36:39], s52 offen sc1
    buffer_load_dwordx4 v[48:51], v244, s[36:39], s52 offen offset:1024 sc1
    buffer_load_dwordx4 v[52:55], v244, s[36:39], s52 offen offset:2048 sc1
    buffer_load_dword v56, v249, s[36:39], s52 offen offset:3072 sc1
    s_branch L_SWN_38
L_SWW_39:
    ds_write_b128 v247, v[44:47]
    ds_write_b128 v247, v[48:51] offset:8192
    ds_write_b128 v247, v[52:55] offset:16384
    s_mov_b64 exec, 1
    ds_add_u32 v251, v255 offset:24
    s_mov_b64 exec, -1
    s_bitset0_b32 s70, 2
L_SWN_38:
    s_bitcmp1_b32 s70, 3
    s_cbranch_scc0 L_SWN_40
    v_add3_u32 v8, v248, v60, v61
    v_add3_u32 v10, v62, v63, v64
    v_add3_u32 v8, v8, v65, v66
    v_add3_u32 v10, v10, v67, v68
    v_add3_u32 v8, v8, v69, v70
    v_add3_u32 v8, v8, v10, v71
    v_cmp_ne_u32 vcc, v8, v72
    v_sub_u32 v60, v60, v248
    v_sub_u32 v64, v64, v248
    v_sub_u32 v68, v68, v248
    s_nop 1
    s_cbranch_vccz L_SWW_41
    s_cmp_eq_u32 s54, 0
    s_cbranch_scc1 L_SWW_41
    s_add_u32 s52, s60, 39936
    buffer_load_dwordx4 v[60:63], v244, s[36:39], s52 offen sc1
    buffer_load_dwordx4 v[64:67], v244, s[36:39], s52 offen offset:1024 sc1
    buffer_load_dwordx4 v[68:71], v244, s[36:39], s52 offen offset:2048 sc1
    buffer_load_dword v72, v249, s[36:39], s52 offen offset:3072 sc1
    s_branch L_SWN_40
L_SWW_41:
    ds_write_b128 v247, v[60:63] offset:256
    ds_write_b128 v247, v[64:67] offset:8448
    ds_write_b128 v247, v[68:71] offset:16640
    s_mov_b64 exec, 1
    ds_add_u32 v251, v255 offset:24
    s_mov_b64 exec, -1
    s_bitset0_b32 s70, 3
L_SWN_40:
    s_cmp_eq_u32 s54, 0x1869f
    s_cbranch_scc0 L_GFC_42
    s_mov_b64 exec, 1
    ds_add_u32 v251, v255 offset:32
    s_mov_b64 exec, -1
L_GFC_42:
    s_cmp_lg_u32 s70, 0
    s_cbranch_scc1 L_SW_33
    s_waitcnt lgkmcnt(0)
    s_mov_b32 s76, 1
    s_branch L_HJ
L_HB:
    s_mov_b32 s76, 3
    buffer_load_dwordx4 v[172:175], v236, s[20:23], s56 offen nt
    buffer_load_dwordx4 v[176:179], v236, s[20:23], s57 offen nt
    buffer_load_dwordx4 v[180:183], v236, s[20:23], s58 offen nt
    buffer_load_dwordx4 v[184:187], v236, s[20:23], s59 offen nt
    buffer_load_dwordx4 v[188:191], v236, s[20:23], s56 offen offset:128 nt
    buffer_load_dwordx4 v[192:195], v236, s[20:23], s57 offen offset:128 nt
    buffer_load_dwordx4 v[196:199], v236, s[20:23], s58 offen offset:128 nt
    buffer_load_dwordx4 v[200:203], v236, s[20:23], s59 offen offset:128 nt
    buffer_load_dwordx4 v[204:207], v236, s[20:23], s56 offen offset:256 nt
    buffer_load_dwordx4 v[208:211], v236, s[20:23], s57 offen offset:256 nt
    buffer_load_dwordx4 v[212:215], v236, s[20:23], s58 offen offset:256 nt
    buffer_load_dwordx4 v[216:219], v236, s[20:23], s59 offen offset:256 nt
    s_waitcnt vmcnt(8)
    ds_write_b128 v237, v[172:175]
    ds_write_b128 v238, v[176:179] offset:1024
    ds_write_b128 v237, v[180:183] offset:2048
    ds_write_b128 v238, v[184:187] offset:3072
    s_waitcnt lgkmcnt(0)
    ds_read_b128 v[172:175], v239
    ds_read_b128 v[176:179], v240
    ds_read_b128 v[180:183], v241
    ds_read_b128 v[184:187], v242
    s_waitcnt lgkmcnt(0)
    s_waitcnt vmcnt(4)
    ds_write_b128 v237, v[188:191]
    ds_write_b128 v238, v[192:195] offset:1024
    ds_write_b128 v237, v[196:199] offset:2048
    ds_write_b128 v238, v[200:203] offset:3072
    s_waitcnt lgkmcnt(0)
    ds_read_b128 v[188:191], v239
    ds_read_b128 v[192:195], v240
    ds_read_b128 v[196:199], v241
    ds_read_b128 v[200:203], v242
    s_waitcnt lgkmcnt(0)
    s_waitcnt vmcnt(0)
    ds_write_b128 v237, v[204:207]
    ds_write_b128 v238, v[208:211] offset:1024
    ds_write_b128 v237, v[212:215] offset:2048
    ds_write_b128 v238, v[216:219] offset:3072
    s_waitcnt lgkmcnt(0)
    ds_read_b128 v[204:207], v239
    ds_read_b128 v[208:211], v240
    ds_read_b128 v[212:215], v241
    ds_read_b128 v[216:219], v242
    s_waitcnt lgkmcnt(0)
    ds_read_b32 v9, v251 offset:28
    s_branch L_LPC_44
L_LP_43:
    s_sleep 1
    ds_read_b32 v9, v251 offset:28
L_LPC_44:
    s_waitcnt lgkmcnt(0)
    v_cmp_gt_u32 vcc, 2, v9
    s_cbranch_vccnz L_LP_43
    s_lshr_b32 s52, s47, 1
    s_lshl_b32 s53, s69, 2
    s_add_u32 s52, s52, s53
    s_mov_b32 s70, 15
    s_bitset0_b32 s70, s52
    s_bitcmp1_b32 s70, 0
    s_cbranch_scc0 L_SWI_45
    s_add_u32 s52, s60, 0
    buffer_load_dwordx4 v[12:15], v244, s[36:39], s52 offen sc1
    buffer_load_dwordx4 v[16:19], v244, s[36:39], s52 offen offset:1024 sc1
    buffer_load_dwordx4 v[20:23], v244, s[36:39], s52 offen offset:2048 sc1
    buffer_load_dword v24, v249, s[36:39], s52 offen offset:3072 sc1
L_SWI_45:
    s_bitcmp1_b32 s70, 1
    s_cbranch_scc0 L_SWI_46
    s_add_u32 s52, s60, 13312
    buffer_load_dwordx4 v[28:31], v244, s[36:39], s52 offen sc1
    buffer_load_dwordx4 v[32:35], v244, s[36:39], s52 offen offset:1024 sc1
    buffer_load_dwordx4 v[36:39], v244, s[36:39], s52 offen offset:2048 sc1
    buffer_load_dword v40, v249, s[36:39], s52 offen offset:3072 sc1
L_SWI_46:
    s_bitcmp1_b32 s70, 2
    s_cbranch_scc0 L_SWI_47
    s_add_u32 s52, s60, 26624
    buffer_load_dwordx4 v[44:47], v244, s[36:39], s52 offen sc1
    buffer_load_dwordx4 v[48:51], v244, s[36:39], s52 offen offset:1024 sc1
    buffer_load_dwordx4 v[52:55], v244, s[36:39], s52 offen offset:2048 sc1
    buffer_load_dword v56, v249, s[36:39], s52 offen offset:3072 sc1
L_SWI_47:
    s_bitcmp1_b32 s70, 3
    s_cbranch_scc0 L_SWI_48
    s_add_u32 s52, s60, 39936
    buffer_load_dwordx4 v[60:63], v244, s[36:39], s52 offen sc1
    buffer_load_dwordx4 v[64:67], v244, s[36:39], s52 offen offset:1024 sc1
    buffer_load_dwordx4 v[68:71], v244, s[36:39], s52 offen offset:2048 sc1
    buffer_load_dword v72, v249, s[36:39], s52 offen offset:3072 sc1
L_SWI_48:
    ds_read_b32 v248, v251 offset:72
    s_mov_b64 exec, 1
    ds_add_u32 v251, v255 offset:32
    s_mov_b64 exec, -1
    s_waitcnt lgkmcnt(0)
    v_add_u32 v248, 0x9e3779b1, v248
    s_mov_b32 s54, 0x186a0
    s_nop 0
L_SW_49:
    s_waitcnt vmcnt(0)
    s_sub_u32 s54, s54, 1
    s_bitcmp1_b32 s70, 0
    s_cbranch_scc0 L_SWN_50
    v_add3_u32 v8, v248, v12, v13
    v_add3_u32 v10, v14, v15, v16
    v_add3_u32 v8, v8, v17, v18
    v_add3_u32 v10, v10, v19, v20
    v_add3_u32 v8, v8, v21, v22
    v_add3_u32 v8, v8, v10, v23
    v_cmp_ne_u32 vcc, v8, v24
    v_sub_u32 v12, v12, v248
    v_sub_u32 v16, v16, v248
    v_sub_u32 v20, v20, v248
    s_nop 1
    s_cbranch_vccz L_SWW_51
    s_cmp_eq_u32 s54, 0
    s_cbranch_scc1 L_SWW_51
    s_add_u32 s52, s60, 0
    buffer_load_dwordx4 v[12:15], v244, s[36:39], s52 offen sc1
    buffer_load_dwordx4 v[16:19], v244, s[36:39], s52 offen offset:1024 sc1
    buffer_load_dwordx4 v[20:23], v244, s[36:39], s52 offen offset:2048 sc1
    buffer_load_dword v24, v249, s[36:39], s52 offen offset:3072 sc1
    s_branch L_SWN_50
L_SWW_51:
    ds_write_b128 v246, v[12:15]
    ds_write_b128 v246, v[16:19] offset:512
    ds_write_b128 v246, v[20:23] offset:1024
    s_mov_b64 exec, 1
    ds_add_u32 v251, v255 offset:20
    s_mov_b64 exec, -1
    s_bitset0_b32 s70, 0
L_SWN_50:
    s_bitcmp1_b32 s70, 1
    s_cbranch_scc0 L_SWN_52
    v_add3_u32 v8, v248, v28, v29
    v_add3_u32 v10, v30, v31, v32
    v_add3_u32 v8, v8, v33, v34
    v_add3_u32 v10, v10, v35, v36
    v_add3_u32 v8, v8, v37, v38
    v_add3_u32 v8, v8, v10, v39
    v_cmp_ne_u32 vcc, v8, v40
    v_sub_u32 v28, v28, v248
    v_sub_u32 v32, v32, v248
    v_sub_u32 v36, v36, v248
    s_nop 1
    s_cbranch_vccz L_SWW_53
    s_cmp_eq_u32 s54, 0
    s_cbranch_scc1 L_SWW_53
    s_add_u32 s52, s60, 13312
    buffer_load_dwordx4 v[28:31], v244, s[36:39], s52 offen sc1
    buffer_load_dwordx4 v[32:35], v244, s[36:39], s52 offen offset:1024 sc1
    buffer_load_dwordx4 v[36:39], v244, s[36:39], s52 offen offset:2048 sc1
    buffer_load_dword v40, v249, s[36:39], s52 offen offset:3072 sc1
    s_branch L_SWN_52
L_SWW_53:
    ds_write_b128 v246, v[28:31] offset:6144
    ds_write_b128 v246, v[32:35] offset:6656
    ds_write_b128 v246, v[36:39] offset:7168
    s_mov_b64 exec, 1
    ds_add_u32 v251, v255 offset:20
    s_mov_b64 exec, -1
    s_bitset0_b32 s70, 1
L_SWN_52:
    s_bitcmp1_b32 s70, 2
    s_cbranch_scc0 L_SWN_54
    v_add3_u32 v8, v248, v44, v45
    v_add3_u32 v10, v46, v47, v48
    v_add3_u32 v8, v8, v49, v50
    v_add3_u32 v10, v10, v51, v52
    v_add3_u32 v8, v8, v53, v54
    v_add3_u32 v8, v8, v10, v55
    v_cmp_ne_u32 vcc, v8, v56
    v_sub_u32 v44, v44, v248
    v_sub_u32 v48, v48, v248
    v_sub_u32 v52, v52, v248
    s_nop 1
    s_cbranch_vccz L_SWW_55
    s_cmp_eq_u32 s54, 0
    s_cbranch_scc1 L_SWW_55
    s_add_u32 s52, s60, 26624
    buffer_load_dwordx4 v[44:47], v244, s[36:39], s52 offen sc1
    buffer_load_dwordx4 v[48:51], v244, s[36:39], s52 offen offset:1024 sc1
    buffer_load_dwordx4 v[52:55], v244, s[36:39], s52 offen offset:2048 sc1
    buffer_load_dword v56, v249, s[36:39], s52 offen offset:3072 sc1
    s_branch L_SWN_54
L_SWW_55:
    ds_write_b128 v247, v[44:47]
    ds_write_b128 v247, v[48:51] offset:8192
    ds_write_b128 v247, v[52:55] offset:16384
    s_mov_b64 exec, 1
    ds_add_u32 v251, v255 offset:24
    s_mov_b64 exec, -1
    s_bitset0_b32 s70, 2
L_SWN_54:
    s_bitcmp1_b32 s70, 3
    s_cbranch_scc0 L_SWN_56
    v_add3_u32 v8, v248, v60, v61
    v_add3_u32 v10, v62, v63, v64
    v_add3_u32 v8, v8, v65, v66
    v_add3_u32 v10, v10, v67, v68
    v_add3_u32 v8, v8, v69, v70
    v_add3_u32 v8, v8, v10, v71
    v_cmp_ne_u32 vcc, v8, v72
    v_sub_u32 v60, v60, v248
    v_sub_u32 v64, v64, v248
    v_sub_u32 v68, v68, v248
    s_nop 1
    s_cbranch_vccz L_SWW_57
    s_cmp_eq_u32 s54, 0
    s_cbranch_scc1 L_SWW_57
    s_add_u32 s52, s60, 39936
    buffer_load_dwordx4 v[60:63], v244, s[36:39], s52 offen sc1
    buffer_load_dwordx4 v[64:67], v244, s[36:39], s52 offen offset:1024 sc1
    buffer_load_dwordx4 v[68:71], v244, s[36:39], s52 offen offset:2048 sc1
    buffer_load_dword v72, v249, s[36:39], s52 offen offset:3072 sc1
    s_branch L_SWN_56
L_SWW_57:
    ds_write_b128 v247, v[60:63] offset:256
    ds_write_b128 v247, v[64:67] offset:8448
    ds_write_b128 v247, v[68:71] offset:16640
    s_mov_b64 exec, 1
    ds_add_u32 v251, v255 offset:24
    s_mov_b64 exec, -1
    s_bitset0_b32 s70, 3
L_SWN_56:
    s_cmp_lg_u32 s70, 0
    s_cbranch_scc1 L_SW_49
    s_waitcnt lgkmcnt(0)
L_HJ:
L_S:
    s_cmp_gt_u32 s76, 0
    s_cbranch_scc1 L_FSN_58
    ds_read_b32 v9, v251 offset:20
    ds_read_b128 v[76:79], v245
    ds_read_b128 v[80:83], v245 offset:1024
    ds_read_b128 v[84:87], v245 offset:2048
    s_waitcnt lgkmcnt(3)
    v_cmp_gt_u32 vcc, 8, v9
    s_cbranch_vccz L_FSG
    s_waitcnt vmcnt(11) lgkmcnt(7)
    ds_write_b128 v237, v[172:175]
    s_waitcnt vmcnt(10)
    ds_write_b128 v238, v[176:179] offset:1024
    s_waitcnt vmcnt(9)
    ds_write_b128 v237, v[180:183] offset:2048
    s_waitcnt vmcnt(8)
    ds_write_b128 v238, v[184:187] offset:3072
    ds_read_b128 v[172:175], v239
    ds_read_b128 v[176:179], v240
    ds_read_b128 v[180:183], v241
    ds_read_b128 v[184:187], v242
    s_waitcnt lgkmcnt(0)
    s_mov_b32 s76, 1
L_FSN_58:
    s_cmp_gt_u32 s76, 1
    s_cbranch_scc1 L_FSN_59
    ds_read_b32 v9, v251 offset:20
    ds_read_b128 v[76:79], v245
    ds_read_b128 v[80:83], v245 offset:1024
    ds_read_b128 v[84:87], v245 offset:2048
    s_waitcnt lgkmcnt(3)
    v_cmp_gt_u32 vcc, 8, v9
    s_cbranch_vccz L_FSG
    s_waitcnt vmcnt(7) lgkmcnt(7)
    ds_write_b128 v237, v[188:191]
    s_waitcnt vmcnt(6)
    ds_write_b128 v238, v[192:195] offset:1024
    s_waitcnt vmcnt(5)
    ds_write_b128 v237, v[196:199] offset:2048
    s_waitcnt vmcnt(4)
    ds_write_b128 v238, v[200:203] offset:3072
    ds_read_b128 v[188:191], v239
    ds_read_b128 v[192:195], v240
    ds_read_b128 v[196:199], v241
    ds_read_b128 v[200:203], v242
    s_waitcnt lgkmcnt(0)
    s_mov_b32 s76, 2
L_FSN_59:
    s_cmp_gt_u32 s76, 2
    s_cbranch_scc1 L_FSN_60
    ds_read_b32 v9, v251 offset:20
    ds_read_b128 v[76:79], v245
    ds_read_b128 v[80:83], v245 offset:1024
    ds_read_b128 v[84:87], v245 offset:2048
    s_waitcnt lgkmcnt(3)
    v_cmp_gt_u32 vcc, 8, v9
    s_cbranch_vccz L_FSG
    s_waitcnt vmcnt(3) lgkmcnt(7)
    ds_write_b128 v237, v[204:207]
    s_waitcnt vmcnt(2)
    ds_write_b128 v238, v[208:211] offset:1024
    s_waitcnt vmcnt(1)
    ds_write_b128 v237, v[212:215] offset:2048
    s_waitcnt vmcnt(0)
    ds_write_b128 v238, v[216:219] offset:3072
    ds_read_b128 v[204:207], v239
    ds_read_b128 v[208:211], v240
    ds_read_b128 v[212:215], v241
    ds_read_b128 v[216:219], v242
    s_waitcnt lgkmcnt(0)
    s_mov_b32 s76, 3
L_FSN_60:
    s_branch L_LPC_62
L_LP_61:
    s_sleep 1
L_LPC_62:
    ds_read_b32 v9, v251 offset:20
    ds_read_b128 v[76:79], v245
    ds_read_b128 v[80:83], v245 offset:1024
    ds_read_b128 v[84:87], v245 offset:2048
    s_waitcnt lgkmcnt(3)
    v_cmp_gt_u32 vcc, 8, v9
    s_cbranch_vccnz L_LP_61
L_FSG:
    s_mov_b32 s63, 0x3dd53b95
    s_cmp_gt_u32 s76, 0
    s_cbranch_scc1 L_FSK_63
    s_waitcnt vmcnt(11) lgkmcnt(7)
    ds_write_b128 v237, v[172:175]
    s_waitcnt vmcnt(10)
    ds_write_b128 v238, v[176:179] offset:1024
    s_waitcnt vmcnt(9)
    ds_write_b128 v237, v[180:183] offset:2048
    s_waitcnt vmcnt(8)
    ds_write_b128 v238, v[184:187] offset:3072
    ds_read_b128 v[172:175], v239
    ds_read_b128 v[176:179], v240
    ds_read_b128 v[180:183], v241
    ds_read_b128 v[184:187], v242
    s_waitcnt lgkmcnt(0)
L_FSK_63:
    s_waitcnt lgkmcnt(2)
    v_mfma_f32_32x32x16_bf16 v[12:27], v[76:79], v[172:175], 0
    ds_read_b128 v[88:91], v245 offset:3072
    ds_read_b128 v[92:95], v245 offset:12288
    s_waitcnt lgkmcnt(3)
    v_mfma_f32_32x32x16_bf16 v[12:27], v[80:83], v[176:179], v[12:27]
    ds_read_b128 v[96:99], v245 offset:13312
    ds_read_b128 v[100:103], v245 offset:14336
    s_waitcnt lgkmcnt(4)
    v_mfma_f32_32x32x16_bf16 v[12:27], v[84:87], v[180:183], v[12:27]
    ds_read_b128 v[104:107], v245 offset:15360
    ds_read_b128 v[108:111], v245 offset:4096
    s_waitcnt lgkmcnt(5)
    v_mfma_f32_32x32x16_bf16 v[12:27], v[88:91], v[184:187], v[12:27]
    ds_read_b128 v[112:115], v245 offset:5120
    ds_read_b128 v[116:119], v245 offset:6144
    s_waitcnt lgkmcnt(6)
    v_mfma_f32_32x32x16_bf16 v[28:43], v[92:95], v[172:175], 0
    ds_read_b128 v[120:123], v245 offset:7168
    s_waitcnt lgkmcnt(6)
    v_mfma_f32_32x32x16_bf16 v[28:43], v[96:99], v[176:179], v[28:43]
    ds_read_b128 v[124:127], v245 offset:16384
    s_waitcnt lgkmcnt(6)
    v_mfma_f32_32x32x16_bf16 v[28:43], v[100:103], v[180:183], v[28:43]
    ds_read_b128 v[128:131], v245 offset:17408
    s_waitcnt lgkmcnt(6)
    v_mfma_f32_32x32x16_bf16 v[28:43], v[104:107], v[184:187], v[28:43]
    ds_read_b128 v[132:135], v245 offset:18432
    s_cmp_gt_u32 s76, 1
    s_cbranch_scc1 L_FSK_64
    s_waitcnt vmcnt(7) lgkmcnt(7)
    ds_write_b128 v237, v[188:191]
    s_waitcnt vmcnt(6)
    ds_write_b128 v238, v[192:195] offset:1024
    s_waitcnt vmcnt(5)
    ds_write_b128 v237, v[196:199] offset:2048
    s_waitcnt vmcnt(4)
    ds_write_b128 v238, v[200:203] offset:3072
    ds_read_b128 v[188:191], v239
    ds_read_b128 v[192:195], v240
    ds_read_b128 v[196:199], v241
    ds_read_b128 v[200:203], v242
    s_waitcnt lgkmcnt(0)
L_FSK_64:
    s_waitcnt lgkmcnt(6)
    v_mfma_f32_32x32x16_bf16 v[12:27], v[108:111], v[188:191], v[12:27]
    ds_read_b128 v[136:139], v245 offset:19456
    s_waitcnt lgkmcnt(6)
    v_mfma_f32_32x32x16_bf16 v[12:27], v[112:115], v[192:195], v[12:27]
    ds_read_b128 v[140:143], v245 offset:8192
    s_lshl_b32 s52, s44, 7
    v_and_b32 v6, 31, v1
    s_waitcnt lgkmcnt(6)
    v_mfma_f32_32x32x16_bf16 v[12:27], v[116:119], v[196:199], v[12:27]
    ds_read_b128 v[144:147], v245 offset:9216
    v_lshl_add_u32 v6, v6, 2, v251
    v_add_u32 v6, s52, v6
    s_waitcnt lgkmcnt(6)
    v_mfma_f32_32x32x16_bf16 v[12:27], v[120:123], v[200:203], v[12:27]
    ds_read_b128 v[148:151], v245 offset:10240
    v_lshrrev_b32 v7, 5, v1
    v_lshl_add_u32 v7, v7, 4, v251
    s_waitcnt lgkmcnt(6)
    v_mfma_f32_32x32x16_bf16 v[28:43], v[124:127], v[188:191], v[28:43]
    ds_read_b128 v[152:155], v245 offset:11264
    ds_read_b32 v9, v251 offset:24
    v_add_u32 v7, s52, v7
    s_waitcnt lgkmcnt(7)
    v_mfma_f32_32x32x16_bf16 v[28:43], v[128:131], v[192:195], v[28:43]
    ds_read_b128 v[156:159], v245 offset:20480
    s_waitcnt lgkmcnt(7)
    v_mfma_f32_32x32x16_bf16 v[28:43], v[132:135], v[196:199], v[28:43]
    ds_read_b128 v[160:163], v245 offset:21504
    s_waitcnt lgkmcnt(7)
    v_mfma_f32_32x32x16_bf16 v[28:43], v[136:139], v[200:203], v[28:43]
    ds_read_b128 v[164:167], v245 offset:22528
    s_cmp_gt_u32 s76, 2
    s_cbranch_scc1 L_FSK_65
    s_waitcnt vmcnt(3) lgkmcnt(7)
    ds_write_b128 v237, v[204:207]
    s_waitcnt vmcnt(2)
    ds_write_b128 v238, v[208:211] offset:1024
    s_waitcnt vmcnt(1)
    ds_write_b128 v237, v[212:215] offset:2048
    s_waitcnt vmcnt(0)
    ds_write_b128 v238, v[216:219] offset:3072
    ds_read_b128 v[204:207], v239
    ds_read_b128 v[208:211], v240
    ds_read_b128 v[212:215], v241
    ds_read_b128 v[216:219], v242
    s_waitcnt lgkmcnt(0)
L_FSK_65:
    s_waitcnt lgkmcnt(7)
    v_mfma_f32_32x32x16_bf16 v[12:27], v[140:143], v[204:207], v[12:27]
    ds_read_b128 v[168:171], v245 offset:23552
    s_waitcnt lgkmcnt(4)
    v_cmp_gt_u32 vcc, 8, v9
    s_cbranch_vccnz L_VW
L_VOK:
    v_mfma_f32_32x32x16_bf16 v[12:27], v[144:147], v[208:211], v[12:27]
    ds_read_b128 v[60:63], v245 offset:24576
    ds_read_b128 v[64:67], v245 offset:28672
    v_mfma_f32_32x32x16_bf16 v[12:27], v[148:151], v[212:215], v[12:27]
    ds_read_b128 v[68:71], v245 offset:32768
    ds_read_b128 v[72:75], v245 offset:36864
    v_mfma_f32_32x32x16_bf16 v[12:27], v[152:155], v[216:219], v[12:27]
    ds_read_b128 v[220:223], v245 offset:40960
    ds_read_b128 v[224:227], v245 offset:45056
    s_waitcnt lgkmcnt(9)
    v_mfma_f32_32x32x16_bf16 v[28:43], v[156:159], v[204:207], v[28:43]
    ds_read_b128 v[228:231], v245 offset:25600
    ds_read_b128 v[232:235], v245 offset:29696
    s_waitcnt lgkmcnt(10)
    v_mfma_f32_32x32x16_bf16 v[28:43], v[160:163], v[208:211], v[28:43]
    v_max3_f32 v2, v12, v13, v14
    v_max3_f32 v2, v2, v15, v16
    v_max3_f32 v2, v2, v17, v18
    ds_read_b128 v[172:175], v245 offset:33792
    ds_read_b128 v[176:179], v245 offset:37888
    s_waitcnt lgkmcnt(11)
    v_mfma_f32_32x32x16_bf16 v[28:43], v[164:167], v[212:215], v[28:43]
    v_max3_f32 v2, v2, v19, v20
    v_max3_f32 v2, v2, v21, v22
    v_max3_f32 v2, v2, v23, v24
    ds_read_b128 v[180:183], v245 offset:41984
    ds_read_b128 v[184:187], v245 offset:46080
    s_waitcnt lgkmcnt(12)
    v_mfma_f32_32x32x16_bf16 v[28:43], v[168:171], v[216:219], v[28:43]
    v_max3_f32 v2, v2, v25, v26
    ds_read_b128 v[188:191], v245 offset:26624
    ds_read_b128 v[192:195], v245 offset:30720
    ds_read_b128 v[196:199], v245 offset:34816
    s_waitcnt lgkmcnt(9)
    ds_read_b128 v[200:203], v245 offset:38912
    s_nop 5
    v_max3_f32 v2, v2, v27, v28
    v_max3_f32 v2, v2, v29, v30
    v_max3_f32 v2, v2, v31, v32
    v_max3_f32 v2, v2, v33, v34
    v_max3_f32 v2, v2, v35, v36
    v_max3_f32 v2, v2, v37, v38
    v_max3_f32 v2, v2, v39, v40
    v_max3_f32 v2, v2, v41, v42
    v_max_f32 v2, v2, v43
    v_mov_b32 v3, v2
    ds_read_b128 v[204:207], v245 offset:43008
    ds_read_b128 v[208:211], v245 offset:47104
    v_permlane32_swap_b32 v2, v3
    v_max_f32 v2, v2, v3
    v_mul_f32 v2, s63, v2
    v_fma_f32 v12, v12, s63, -v2
    v_fma_f32 v13, v13, s63, -v2
    v_fma_f32 v14, v14, s63, -v2
    v_fma_f32 v15, v15, s63, -v2
    v_fma_f32 v16, v16, s63, -v2
    v_fma_f32 v17, v17, s63, -v2
    v_fma_f32 v18, v18, s63, -v2
    v_fma_f32 v19, v19, s63, -v2
    v_exp_f32 v12, v12
    v_exp_f32 v13, v13
    v_exp_f32 v14, v14
    v_exp_f32 v15, v15
    v_cvt_pk_bf16_f32 v44, v12, v13
    v_exp_f32 v16, v16
    v_exp_f32 v17, v17
    v_cvt_pk_bf16_f32 v45, v14, v15
    v_exp_f32 v18, v18
    v_exp_f32 v19, v19
    v_cvt_pk_bf16_f32 v46, v16, v17
    v_fma_f32 v20, v20, s63, -v2
    v_cvt_pk_bf16_f32 v47, v18, v19
    v_fma_f32 v21, v21, s63, -v2
    v_fma_f32 v22, v22, s63, -v2
    v_mfma_f32_32x32x16_bf16 v[76:91], v[44:47], v[60:63], 0
    ds_read_b128 v[212:215], v245 offset:27648
    v_exp_f32 v20, v20
    v_fma_f32 v23, v23, s63, -v2
    v_exp_f32 v21, v21
    v_mfma_f32_32x32x16_bf16 v[92:107], v[44:47], v[64:67], 0
    ds_read_b128 v[216:219], v245 offset:31744
    v_exp_f32 v22, v22
    v_fma_f32 v24, v24, s63, -v2
    v_cvt_pk_bf16_f32 v48, v20, v21
    v_fma_f32 v25, v25, s63, -v2
    v_add_f32 v4, v12, v13
    v_mfma_f32_32x32x16_bf16 v[108:123], v[44:47], v[68:71], 0
    ds_read_b128 v[60:63], v245 offset:35840
    v_exp_f32 v23, v23
    v_fma_f32 v26, v26, s63, -v2
    v_exp_f32 v24, v24
    v_mfma_f32_32x32x16_bf16 v[124:139], v[44:47], v[72:75], 0
    s_waitcnt lgkmcnt(9)
    ds_read_b128 v[64:67], v245 offset:39936
    v_exp_f32 v25, v25
    v_cvt_pk_bf16_f32 v49, v22, v23
    v_fma_f32 v27, v27, s63, -v2
    v_add_f32 v5, v14, v15
    v_add_f32 v4, v4, v16
    v_mfma_f32_32x32x16_bf16 v[140:155], v[44:47], v[220:223], 0
    ds_read_b128 v[68:71], v245 offset:44032
    v_exp_f32 v26, v26
    v_cvt_pk_bf16_f32 v50, v24, v25
    v_exp_f32 v27, v27
    v_add_f32 v5, v5, v17
    v_mfma_f32_32x32x16_bf16 v[156:171], v[44:47], v[224:227], 0
    ds_read_b128 v[72:75], v245 offset:48128
    v_fma_f32 v28, v28, s63, -v2
    v_cvt_pk_bf16_f32 v51, v26, v27
    v_fma_f32 v29, v29, s63, -v2
    v_fma_f32 v30, v30, s63, -v2
    v_add_f32 v4, v4, v18
    v_add_f32 v5, v5, v19
    v_mfma_f32_32x32x16_bf16 v[76:91], v[48:51], v[228:231], v[76:91]
    v_exp_f32 v28, v28
    v_fma_f32 v31, v31, s63, -v2
    v_exp_f32 v29, v29
    v_add_f32 v4, v4, v20
    v_mfma_f32_32x32x16_bf16 v[92:107], v[48:51], v[232:235], v[92:107]
    v_exp_f32 v30, v30
    v_fma_f32 v32, v32, s63, -v2
    v_cvt_pk_bf16_f32 v52, v28, v29
    v_fma_f32 v33, v33, s63, -v2
    v_add_f32 v5, v5, v21
    v_mfma_f32_32x32x16_bf16 v[108:123], v[48:51], v[172:175], v[108:123]
    v_exp_f32 v31, v31
    v_fma_f32 v34, v34, s63, -v2
    v_exp_f32 v32, v32
    v_add_f32 v4, v4, v22
    v_mfma_f32_32x32x16_bf16 v[124:139], v[48:51], v[176:179], v[124:139]
    v_exp_f32 v33, v33
    v_cvt_pk_bf16_f32 v53, v30, v31
    v_fma_f32 v35, v35, s63, -v2
    v_add_f32 v5, v5, v23
    v_add_f32 v4, v4, v24
    v_mfma_f32_32x32x16_bf16 v[140:155], v[48:51], v[180:183], v[140:155]
    v_exp_f32 v34, v34
    v_cvt_pk_bf16_f32 v54, v32, v33
    v_exp_f32 v35, v35
    v_add_f32 v5, v5, v25
    v_mfma_f32_32x32x16_bf16 v[156:171], v[48:51], v[184:187], v[156:171]
    v_fma_f32 v36, v36, s63, -v2
    v_cvt_pk_bf16_f32 v55, v34, v35
    v_fma_f32 v37, v37, s63, -v2
    v_fma_f32 v38, v38, s63, -v2
    v_add_f32 v4, v4, v26
    v_add_f32 v5, v5, v27
    s_waitcnt lgkmcnt(6)
    v_mfma_f32_32x32x16_bf16 v[76:91], v[52:55], v[188:191], v[76:91]
    v_exp_f32 v36, v36
    v_fma_f32 v39, v39, s63, -v2
    v_exp_f32 v37, v37
    v_add_f32 v4, v4, v28
    v_mfma_f32_32x32x16_bf16 v[92:107], v[52:55], v[192:195], v[92:107]
    v_exp_f32 v38, v38
    v_fma_f32 v40, v40, s63, -v2
    v_cvt_pk_bf16_f32 v56, v36, v37
    v_fma_f32 v41, v41, s63, -v2
    v_add_f32 v5, v5, v29
    v_mfma_f32_32x32x16_bf16 v[108:123], v[52:55], v[196:199], v[108:123]
    v_exp_f32 v39, v39
    v_fma_f32 v42, v42, s63, -v2
    v_exp_f32 v40, v40
    v_add_f32 v4, v4, v30
    v_mfma_f32_32x32x16_bf16 v[124:139], v[52:55], v[200:203], v[124:139]
    v_exp_f32 v41, v41
    v_cvt_pk_bf16_f32 v57, v38, v39
    v_fma_f32 v43, v43, s63, -v2
    v_add_f32 v5, v5, v31
    v_add_f32 v4, v4, v32
    v_mfma_f32_32x32x16_bf16 v[140:155], v[52:55], v[204:207], v[140:155]
    v_exp_f32 v42, v42
    v_cvt_pk_bf16_f32 v58, v40, v41
    v_exp_f32 v43, v43
    v_add_f32 v5, v5, v33
    v_mfma_f32_32x32x16_bf16 v[156:171], v[52:55], v[208:211], v[156:171]
    v_cvt_pk_bf16_f32 v59, v42, v43
    v_add_f32 v4, v4, v34
    v_add_f32 v5, v5, v35
    s_waitcnt lgkmcnt(3)
    v_mfma_f32_32x32x16_bf16 v[76:91], v[56:59], v[212:215], v[76:91]
    v_add_f32 v4, v4, v36
    v_add_f32 v5, v5, v37
    v_add_f32 v4, v4, v38
    v_add_f32 v5, v5, v39
    v_add_f32 v4, v4, v40
    v_add_f32 v5, v5, v41
    v_mfma_f32_32x32x16_bf16 v[92:107], v[56:59], v[216:219], v[92:107]
    v_add_f32 v4, v4, v42
    v_add_f32 v5, v5, v43
    v_add_f32 v4, v4, v5
    v_mov_b32 v3, v4
    v_mfma_f32_32x32x16_bf16 v[108:123], v[56:59], v[60:63], v[108:123]
    s_nop 0
    v_permlane32_swap_b32 v4, v3
    v_add_f32 v4, v4, v3
    v_rcp_f32 v4, v4
    s_nop 0
    ds_write_b32 v6, v4 offset:256
    ds_read_b128 v[220:223], v7 offset:256
    ds_read_b128 v[224:227], v7 offset:288
    ds_read_b128 v[228:231], v7 offset:320
    ds_read_b128 v[232:235], v7 offset:352
    s_waitcnt lgkmcnt(5)
    v_mfma_f32_32x32x16_bf16 v[124:139], v[56:59], v[64:67], v[124:139]
    v_mfma_f32_32x32x16_bf16 v[140:155], v[56:59], v[68:71], v[140:155]
    v_mfma_f32_32x32x16_bf16 v[156:171], v[56:59], v[72:75], v[156:171]
    s_waitcnt lgkmcnt(3)
    v_mul_f32 v76, v76, v220
    v_mul_f32 v92, v92, v220
    v_cvt_pk_bf16_f32 v12, v76, v92
    v_mul_f32 v108, v108, v220
    v_mul_f32 v124, v124, v220
    v_cvt_pk_bf16_f32 v13, v108, v124
    v_mul_f32 v77, v77, v221
    v_mul_f32 v93, v93, v221
    v_cvt_pk_bf16_f32 v16, v77, v93
    v_mul_f32 v109, v109, v221
    v_mul_f32 v125, v125, v221
    v_cvt_pk_bf16_f32 v17, v109, v125
    v_mul_f32 v140, v140, v220
    v_mul_f32 v156, v156, v220
    v_cvt_pk_bf16_f32 v14, v140, v156
    s_cmp_ge_u32 s44, 4
    buffer_store_dwordx3 v[12:14], v243, s[32:35], s56 offen nt
    v_mul_f32 v141, v141, v221
    v_mul_f32 v157, v157, v221
    v_cvt_pk_bf16_f32 v18, v141, v157
    buffer_store_dwordx3 v[16:18], v243, s[32:35], s56 offen offset:384 nt
    v_mul_f32 v78, v78, v222
    v_mul_f32 v94, v94, v222
    v_cvt_pk_bf16_f32 v20, v78, v94
    v_mul_f32 v110, v110, v222
    v_mul_f32 v126, v126, v222
    v_cvt_pk_bf16_f32 v21, v110, v126
    v_mul_f32 v142, v142, v222
    v_mul_f32 v158, v158, v222
    v_cvt_pk_bf16_f32 v22, v142, v158
    buffer_store_dwordx3 v[20:22], v243, s[32:35], s56 offen offset:768 nt
    v_mul_f32 v79, v79, v223
    v_mul_f32 v95, v95, v223
    v_cvt_pk_bf16_f32 v24, v79, v95
    v_mul_f32 v111, v111, v223
    v_mul_f32 v127, v127, v223
    v_cvt_pk_bf16_f32 v25, v111, v127
    v_mul_f32 v143, v143, v223
    v_mul_f32 v159, v159, v223
    v_cvt_pk_bf16_f32 v26, v143, v159
    s_cbranch_scc0 L_STH_66
    s_waitcnt vmcnt(2)
L_STH_66:
    buffer_store_dwordx3 v[24:26], v243, s[32:35], s56 offen offset:1152 nt
    s_waitcnt lgkmcnt(2)
    v_mul_f32 v80, v80, v224
    v_mul_f32 v96, v96, v224
    v_cvt_pk_bf16_f32 v28, v80, v96
    v_mul_f32 v112, v112, v224
    v_mul_f32 v128, v128, v224
    v_cvt_pk_bf16_f32 v29, v112, v128
    v_mul_f32 v144, v144, v224
    v_mul_f32 v160, v160, v224
    v_cvt_pk_bf16_f32 v30, v144, v160
    s_cbranch_scc0 L_STH_67
    s_waitcnt vmcnt(2)
L_STH_67:
    buffer_store_dwordx3 v[28:30], v243, s[32:35], s57 offen nt
    v_mul_f32 v81, v81, v225
    v_mul_f32 v97, v97, v225
    v_cvt_pk_bf16_f32 v32, v81, v97
    v_mul_f32 v113, v113, v225
    v_mul_f32 v129, v129, v225
    v_cvt_pk_bf16_f32 v33, v113, v129
    v_mul_f32 v145, v145, v225
    v_mul_f32 v161, v161, v225
    v_cvt_pk_bf16_f32 v34, v145, v161
    s_cbranch_scc0 L_STH_68
    s_waitcnt vmcnt(2)
L_STH_68:
    buffer_store_dwordx3 v[32:34], v243, s[32:35], s57 offen offset:384 nt
    v_mul_f32 v82, v82, v226
    v_mul_f32 v98, v98, v226
    v_cvt_pk_bf16_f32 v36, v82, v98
    v_mul_f32 v114, v114, v226
    v_mul_f32 v130, v130, v226
    v_cvt_pk_bf16_f32 v37, v114, v130
    v_mul_f32 v146, v146, v226
    v_mul_f32 v162, v162, v226
    v_cvt_pk_bf16_f32 v38, v146, v162
    s_cbranch_scc0 L_STH_69
    s_waitcnt vmcnt(2)
L_STH_69:
    buffer_store_dwordx3 v[36:38], v243, s[32:35], s57 offen offset:768 nt
    v_mul_f32 v83, v83, v227
    v_mul_f32 v99, v99, v227
    v_cvt_pk_bf16_f32 v40, v83, v99
    v_mul_f32 v115, v115, v227
    v_mul_f32 v131, v131, v227
    v_cvt_pk_bf16_f32 v41, v115, v131
    v_mul_f32 v147, v147, v227
    v_mul_f32 v163, v163, v227
    v_cvt_pk_bf16_f32 v42, v147, v163
    s_cbranch_scc0 L_STH_70
    s_waitcnt vmcnt(2)
L_STH_70:
    buffer_store_dwordx3 v[40:42], v243, s[32:35], s57 offen offset:1152 nt
    s_waitcnt lgkmcnt(1)
    v_mul_f32 v84, v84, v228
    v_mul_f32 v100, v100, v228
    v_cvt_pk_bf16_f32 v12, v84, v100
    v_mul_f32 v116, v116, v228
    v_mul_f32 v132, v132, v228
    v_cvt_pk_bf16_f32 v13, v116, v132
    v_mul_f32 v148, v148, v228
    v_mul_f32 v164, v164, v228
    v_cvt_pk_bf16_f32 v14, v148, v164
    s_cbranch_scc0 L_STH_71
    s_waitcnt vmcnt(2)
L_STH_71:
    buffer_store_dwordx3 v[12:14], v243, s[32:35], s58 offen nt
    v_mul_f32 v85, v85, v229
    v_mul_f32 v101, v101, v229
    v_cvt_pk_bf16_f32 v16, v85, v101
    v_mul_f32 v117, v117, v229
    v_mul_f32 v133, v133, v229
    v_cvt_pk_bf16_f32 v17, v117, v133
    v_mul_f32 v149, v149, v229
    v_mul_f32 v165, v165, v229
    v_cvt_pk_bf16_f32 v18, v149, v165
    s_cbranch_scc0 L_STH_72
    s_waitcnt vmcnt(2)
L_STH_72:
    buffer_store_dwordx3 v[16:18], v243, s[32:35], s58 offen offset:384 nt
    v_mul_f32 v86, v86, v230
    v_mul_f32 v102, v102, v230
    v_cvt_pk_bf16_f32 v20, v86, v102
    v_mul_f32 v118, v118, v230
    v_mul_f32 v134, v134, v230
    v_cvt_pk_bf16_f32 v21, v118, v134
    v_mul_f32 v150, v150, v230
    v_mul_f32 v166, v166, v230
    v_cvt_pk_bf16_f32 v22, v150, v166
    s_cbranch_scc0 L_STH_73
    s_waitcnt vmcnt(2)
L_STH_73:
    buffer_store_dwordx3 v[20:22], v243, s[32:35], s58 offen offset:768 nt
    v_mul_f32 v87, v87, v231
    v_mul_f32 v103, v103, v231
    v_cvt_pk_bf16_f32 v24, v87, v103
    v_mul_f32 v119, v119, v231
    v_mul_f32 v135, v135, v231
    v_cvt_pk_bf16_f32 v25, v119, v135
    v_mul_f32 v151, v151, v231
    v_mul_f32 v167, v167, v231
    v_cvt_pk_bf16_f32 v26, v151, v167
    s_cbranch_scc0 L_STH_74
    s_waitcnt vmcnt(2)
L_STH_74:
    buffer_store_dwordx3 v[24:26], v243, s[32:35], s58 offen offset:1152 nt
    s_waitcnt lgkmcnt(0)
    v_mul_f32 v88, v88, v232
    v_mul_f32 v104, v104, v232
    v_cvt_pk_bf16_f32 v28, v88, v104
    v_mul_f32 v120, v120, v232
    v_mul_f32 v136, v136, v232
    v_cvt_pk_bf16_f32 v29, v120, v136
    v_mul_f32 v152, v152, v232
    v_mul_f32 v168, v168, v232
    v_cvt_pk_bf16_f32 v30, v152, v168
    s_cbranch_scc0 L_STH_75
    s_waitcnt vmcnt(2)
L_STH_75:
    buffer_store_dwordx3 v[28:30], v243, s[32:35], s59 offen nt
    v_mul_f32 v89, v89, v233
    v_mul_f32 v105, v105, v233
    v_cvt_pk_bf16_f32 v32, v89, v105
    v_mul_f32 v121, v121, v233
    v_mul_f32 v137, v137, v233
    v_cvt_pk_bf16_f32 v33, v121, v137
    v_mul_f32 v153, v153, v233
    v_mul_f32 v169, v169, v233
    v_cvt_pk_bf16_f32 v34, v153, v169
    s_cbranch_scc0 L_STH_76
    s_waitcnt vmcnt(2)
L_STH_76:
    buffer_store_dwordx3 v[32:34], v243, s[32:35], s59 offen offset:384 nt
    v_mul_f32 v90, v90, v234
    v_mul_f32 v106, v106, v234
    v_cvt_pk_bf16_f32 v36, v90, v106
    v_mul_f32 v122, v122, v234
    v_mul_f32 v138, v138, v234
    v_cvt_pk_bf16_f32 v37, v122, v138
    v_mul_f32 v154, v154, v234
    v_mul_f32 v170, v170, v234
    v_cvt_pk_bf16_f32 v38, v154, v170
    s_cbranch_scc0 L_STH_77
    s_waitcnt vmcnt(2)
L_STH_77:
    buffer_store_dwordx3 v[36:38], v243, s[32:35], s59 offen offset:768 nt
    v_mul_f32 v91, v91, v235
    v_mul_f32 v107, v107, v235
    v_cvt_pk_bf16_f32 v40, v91, v107
    v_mul_f32 v123, v123, v235
    v_mul_f32 v139, v139, v235
    v_cvt_pk_bf16_f32 v41, v123, v139
    v_mul_f32 v155, v155, v235
    v_mul_f32 v171, v171, v235
    v_cvt_pk_bf16_f32 v42, v155, v171
    s_cbranch_scc0 L_STH_78
    s_waitcnt vmcnt(2)
L_STH_78:
    buffer_store_dwordx3 v[40:42], v243, s[32:35], s59 offen offset:1152 nt
    s_nop 1
L_END:
    s_endpgm
L_VW:
    s_sleep 1
    ds_read_b32 v9, v251 offset:24
    s_waitcnt lgkmcnt(0)
    v_cmp_gt_u32 vcc, 8, v9
    s_cbranch_vccnz L_VW
    s_branch L_VOK
.section .rodata,"a"
.p2align 6
.amdhsa_kernel standalone__low_rank_proj_linformer__prompt_kernel
  .amdhsa_next_free_vgpr 256
  .amdhsa_next_free_sgpr 102
  .amdhsa_accum_offset 256
  .amdhsa_group_segment_fixed_size 0
  .amdhsa_kernarg_size 64
  .amdhsa_user_sgpr_count 2
  .amdhsa_user_sgpr_kernarg_segment_ptr 1
  .amdhsa_system_sgpr_workgroup_id_x 1
.end_amdhsa_kernel
```
